```python
import torch

def _softmax(x, axis=-1):
    return torch.softmax(x, dim=axis)
def _gelu(x):
    return torch.nn.functional.gelu(x, approximate="tanh")
def _silu(x):
    return torch.nn.functional.silu(x)
def _sigmoid(x):
    return torch.sigmoid(x)
def _layernorm(x, axis=-1, eps=1e-5):
    m = x.mean(dim=axis, keepdim=True)
    v = x.var(dim=axis, keepdim=True, unbiased=False)
    return (x - m) / torch.sqrt(v + eps)
def _scatter_add(tgt, idx, src, axis=0):
    return tgt.clone().index_add_(axis, idx, src)
def _segment_sum(src, seg, n):
    out = torch.zeros((n,) + src.shape[1:], dtype=src.dtype)
    return out.index_add_(0, seg, src)
def _pad(x, pw):
    flat = tuple(v for pair in reversed(pw) for v in pair)
    return torch.nn.functional.pad(x, flat)

kernel_name = 'standalone__structured_sparse_n_m__ragged'

def setup_inputs():

    _w = (lambda a: (lambda t: t.to(torch.bfloat16) if t.is_floating_point() else t)(torch.as_tensor(a)))
    B, S, D = 16, 512, 1024
    assert D % 4 == 0, "d_model must be divisible by M=4 for 2:4 sparsity"
    return {
        "x": _w((lambda *s: torch.randn(*s, dtype=torch.bfloat16) * 0.05)(B, S, D)),
        "w": _w((lambda *s: torch.randn(*s, dtype=torch.bfloat16) * 0.05)(D, D)),
        "b": _w((lambda *s: torch.randn(*s, dtype=torch.bfloat16) * 0.05)(D)),
    }

def reference(x, w, b):
    B, S, D = x.shape
    N, M = 2, 4
    G = D // M
    wg = w.reshape(G, M, D)
    mag = torch.abs(wg)
    order = torch.argsort(mag, 1)
    thr = (lambda x, i, axis: torch.take_along_dim(x, i, dim=axis))(mag, order[:, M - N:M - N + 1, :], 1)
    mask = (lambda x, dt: x.to(dt))(mag >= thr, w.dtype)
    wp = (wg * mask).reshape(D, D)
    return torch.einsum("bsd,df->bsf", x, wp) + b
```

```asm
; @launch grid=(256,1,1) block=(512,1,1) lds=163840
.amdgcn_target "amdgcn-amd-amdhsa--gfx950"
.text
.globl standalone__structured_sparse_n_m__ragged_kernel
.p2align 8
.type standalone__structured_sparse_n_m__ragged_kernel,@function
standalone__structured_sparse_n_m__ragged_kernel:
    s_cmp_ge_u32 s2, 256
    s_cbranch_scc1 L_done

    s_load_dwordx4 s[4:7], s[0:1], 0
    s_load_dwordx4 s[8:11], s[0:1], 16
    s_load_dwordx2 s[12:13], s[0:1], 40
    v_lshrrev_b32 v1, 6, v0
    v_and_b32 v0, 63, v0
    s_and_b32 s14, s2, 7
    s_lshr_b32 s15, s2, 3
    s_lshr_b32 s16, s15, 3
    s_lshl_b32 s14, s14, 2
    s_add_u32 s14, s14, s16
    s_and_b32 s15, s15, 7
    v_readfirstlane_b32 s16, v1
    s_waitcnt lgkmcnt(0)
    s_cmp_ge_u32 s16, 4
    s_cbranch_scc1 L_producer

    s_lshr_b32 s17, s16, 1
    s_and_b32 s18, s16, 1
    v_lshrrev_b32 v2, 5, v0
    v_and_b32 v3, 31, v0
    s_mov_b32 s20, s8
    s_and_b32 s21, s9, 0xffff
    s_movk_i32 s22, 0x800
    s_mov_b32 s23, 0x00020000
    s_mov_b32 s24, s10
    s_and_b32 s25, s11, 0xffff
    s_mov_b32 s26, 0x1000000
    s_mov_b32 s27, 0x00020000
    s_lshl_b32 s19, s15, 8
    s_lshl_b32 s28, s18, 7
    s_add_u32 s19, s19, s28
    v_lshl_add_u32 v4, v2, 5, s19
    buffer_load_dwordx4 v[32:35], v4, s[20:23], 0 offen
    buffer_load_dwordx4 v[36:39], v4, s[20:23], 0 offen offset:16
    buffer_load_dwordx4 v[40:43], v4, s[20:23], 0 offen offset:64
    buffer_load_dwordx4 v[44:47], v4, s[20:23], 0 offen offset:80
    v_bfe_u32 v5, v0, 1, 3
    s_lshl_b32 s28, s17, 14
    v_lshl_add_u32 v6, v3, 7, s28

    v_or_b32 v7, 0, v2
    v_xor_b32 v7, v7, v5
    v_lshl_add_u32 v8, v7, 4, v6
    v_or_b32 v7, 2, v2
    v_xor_b32 v7, v7, v5
    v_lshl_add_u32 v9, v7, 4, v6
    v_or_b32 v7, 4, v2
    v_xor_b32 v7, v7, v5
    v_lshl_add_u32 v10, v7, 4, v6
    v_or_b32 v7, 6, v2
    v_xor_b32 v7, v7, v5
    v_lshl_add_u32 v11, v7, 4, v6
    v_bfe_u32 v5, v0, 2, 2
    v_lshl_add_u32 v6, v2, 3, v5
    v_lshlrev_b32 v6, 8, v6
    v_add_u32 v6, 131072, v6
    v_and_b32 v7, 1, v0
    v_lshlrev_b32 v7, 2, v7
    v_bfe_u32 v21, v0, 1, 1
    v_bfe_u32 v22, v0, 4, 1
    v_lshl_add_u32 v21, v22, 1, v21
    v_add_u32 v7, v7, v21
    v_lshl_add_u32 v6, v7, 3, v6
    s_lshl_b32 s28, s18, 1
    v_xor_b32 v7, s28, v5
    v_lshl_add_u32 v12, v7, 6, v6
    s_add_u32 s28, s28, 1
    v_xor_b32 v7, s28, v5
    v_lshl_add_u32 v13, v7, 6, v6
    v_lshlrev_b32 v14, 4, v0
    v_add_u32 v14, 131072, v14
    s_mov_b32 s30, 0
    s_mov_b32 s31, 0
    s_movk_i32 s29, 0x4000
    s_lshl_b32 s28, s16, 14
    v_and_b32 v5, 7, v0
    v_lshl_add_u32 v6, v3, 7, s28
    v_lshlrev_b32 v7, 1, v2

    v_or_b32 v21, 0, v7
    v_xor_b32 v21, v21, v5
    v_lshl_add_u32 v24, v21, 4, v6
    v_or_b32 v21, 1, v7
    v_xor_b32 v21, v21, v5
    v_lshl_add_u32 v25, v21, 4, v6
    v_or_b32 v21, 4, v7
    v_xor_b32 v21, v21, v5
    v_lshl_add_u32 v26, v21, 4, v6
    v_or_b32 v21, 5, v7
    v_xor_b32 v21, v21, v5
    v_lshl_add_u32 v27, v21, 4, v6
    v_lshrrev_b32 v21, 3, v0
    v_and_b32 v22, 7, v21
    v_xor_b32 v22, v22, v5
    v_lshl_add_u32 v28, v21, 7, s28
    v_lshl_add_u32 v28, v22, 4, v28
    v_lshlrev_b32 v29, 11, v21
    v_lshl_add_u32 v29, v5, 4, v29
    s_lshl_b32 s32, s14, 19
    s_lshl_b32 s33, s17, 18
    s_add_u32 s32, s32, s33
    s_add_u32 s32, s32, s19
    s_waitcnt vmcnt(0)

    v_lshlrev_b32 v128, 16, v32
    v_lshlrev_b32 v160, 16, v32
    v_lshlrev_b32 v192, 16, v32
    v_lshlrev_b32 v224, 16, v32
    v_and_b32 v129, 0xffff0000, v32
    v_and_b32 v161, 0xffff0000, v32
    v_and_b32 v193, 0xffff0000, v32
    v_and_b32 v225, 0xffff0000, v32
    v_lshlrev_b32 v130, 16, v33
    v_lshlrev_b32 v162, 16, v33
    v_lshlrev_b32 v194, 16, v33
    v_lshlrev_b32 v226, 16, v33
    v_and_b32 v131, 0xffff0000, v33
    v_and_b32 v163, 0xffff0000, v33
    v_and_b32 v195, 0xffff0000, v33
    v_and_b32 v227, 0xffff0000, v33
    v_lshlrev_b32 v132, 16, v34
    v_lshlrev_b32 v164, 16, v34
    v_lshlrev_b32 v196, 16, v34
    v_lshlrev_b32 v228, 16, v34
    v_and_b32 v133, 0xffff0000, v34
    v_and_b32 v165, 0xffff0000, v34
    v_and_b32 v197, 0xffff0000, v34
    v_and_b32 v229, 0xffff0000, v34
    v_lshlrev_b32 v134, 16, v35
    v_lshlrev_b32 v166, 16, v35
    v_lshlrev_b32 v198, 16, v35
    v_lshlrev_b32 v230, 16, v35
    v_and_b32 v135, 0xffff0000, v35
    v_and_b32 v167, 0xffff0000, v35
    v_and_b32 v199, 0xffff0000, v35
    v_and_b32 v231, 0xffff0000, v35
    v_lshlrev_b32 v136, 16, v36
    v_lshlrev_b32 v168, 16, v36
    v_lshlrev_b32 v200, 16, v36
    v_lshlrev_b32 v232, 16, v36
    v_and_b32 v137, 0xffff0000, v36
    v_and_b32 v169, 0xffff0000, v36
    v_and_b32 v201, 0xffff0000, v36
    v_and_b32 v233, 0xffff0000, v36
    v_lshlrev_b32 v138, 16, v37
    v_lshlrev_b32 v170, 16, v37
    v_lshlrev_b32 v202, 16, v37
    v_lshlrev_b32 v234, 16, v37
    v_and_b32 v139, 0xffff0000, v37
    v_and_b32 v171, 0xffff0000, v37
    v_and_b32 v203, 0xffff0000, v37
    v_and_b32 v235, 0xffff0000, v37
    v_lshlrev_b32 v140, 16, v38
    v_lshlrev_b32 v172, 16, v38
    v_lshlrev_b32 v204, 16, v38
    v_lshlrev_b32 v236, 16, v38
    v_and_b32 v141, 0xffff0000, v38
    v_and_b32 v173, 0xffff0000, v38
    v_and_b32 v205, 0xffff0000, v38
    v_and_b32 v237, 0xffff0000, v38
    v_lshlrev_b32 v142, 16, v39
    v_lshlrev_b32 v174, 16, v39
    v_lshlrev_b32 v206, 16, v39
    v_lshlrev_b32 v238, 16, v39
    v_and_b32 v143, 0xffff0000, v39
    v_and_b32 v175, 0xffff0000, v39
    v_and_b32 v207, 0xffff0000, v39
    v_and_b32 v239, 0xffff0000, v39
    v_lshlrev_b32 v144, 16, v40
    v_lshlrev_b32 v176, 16, v40
    v_lshlrev_b32 v208, 16, v40
    v_lshlrev_b32 v240, 16, v40
    v_and_b32 v145, 0xffff0000, v40
    v_and_b32 v177, 0xffff0000, v40
    v_and_b32 v209, 0xffff0000, v40
    v_and_b32 v241, 0xffff0000, v40
    v_lshlrev_b32 v146, 16, v41
    v_lshlrev_b32 v178, 16, v41
    v_lshlrev_b32 v210, 16, v41
    v_lshlrev_b32 v242, 16, v41
    v_and_b32 v147, 0xffff0000, v41
    v_and_b32 v179, 0xffff0000, v41
    v_and_b32 v211, 0xffff0000, v41
    v_and_b32 v243, 0xffff0000, v41
    v_lshlrev_b32 v148, 16, v42
    v_lshlrev_b32 v180, 16, v42
    v_lshlrev_b32 v212, 16, v42
    v_lshlrev_b32 v244, 16, v42
    v_and_b32 v149, 0xffff0000, v42
    v_and_b32 v181, 0xffff0000, v42
    v_and_b32 v213, 0xffff0000, v42
    v_and_b32 v245, 0xffff0000, v42
    v_lshlrev_b32 v150, 16, v43
    v_lshlrev_b32 v182, 16, v43
    v_lshlrev_b32 v214, 16, v43
    v_lshlrev_b32 v246, 16, v43
    v_and_b32 v151, 0xffff0000, v43
    v_and_b32 v183, 0xffff0000, v43
    v_and_b32 v215, 0xffff0000, v43
    v_and_b32 v247, 0xffff0000, v43
    v_lshlrev_b32 v152, 16, v44
    v_lshlrev_b32 v184, 16, v44
    v_lshlrev_b32 v216, 16, v44
    v_lshlrev_b32 v248, 16, v44
    v_and_b32 v153, 0xffff0000, v44
    v_and_b32 v185, 0xffff0000, v44
    v_and_b32 v217, 0xffff0000, v44
    v_and_b32 v249, 0xffff0000, v44
    v_lshlrev_b32 v154, 16, v45
    v_lshlrev_b32 v186, 16, v45
    v_lshlrev_b32 v218, 16, v45
    v_lshlrev_b32 v250, 16, v45
    v_and_b32 v155, 0xffff0000, v45
    v_and_b32 v187, 0xffff0000, v45
    v_and_b32 v219, 0xffff0000, v45
    v_and_b32 v251, 0xffff0000, v45
    v_lshlrev_b32 v156, 16, v46
    v_lshlrev_b32 v188, 16, v46
    v_lshlrev_b32 v220, 16, v46
    v_lshlrev_b32 v252, 16, v46
    v_and_b32 v157, 0xffff0000, v46
    v_and_b32 v189, 0xffff0000, v46
    v_and_b32 v221, 0xffff0000, v46
    v_and_b32 v253, 0xffff0000, v46
    v_lshlrev_b32 v158, 16, v47
    v_lshlrev_b32 v190, 16, v47
    v_lshlrev_b32 v222, 16, v47
    v_lshlrev_b32 v254, 16, v47
    v_and_b32 v159, 0xffff0000, v47
    v_and_b32 v191, 0xffff0000, v47
    v_and_b32 v223, 0xffff0000, v47
    v_and_b32 v255, 0xffff0000, v47
    s_barrier
    ds_read_b64_tr_b16 v[64:65], v12 offset:0
    ds_read_b64_tr_b16 v[66:67], v12 offset:1024
    ds_read_b128 v[72:75], v8 offset:0
    ds_read_b64_tr_b16 v[68:69], v13 offset:0
    ds_read_b64_tr_b16 v[70:71], v13 offset:1024
    ds_read_b128 v[76:79], v8 offset:4096
    ds_read_b128 v[80:83], v8 offset:8192
    ds_read_b128 v[84:87], v8 offset:12288
L_cons_loop:
    s_waitcnt lgkmcnt(0)
    v_mfma_f32_32x32x16_bf16 v[128:143], v[64:67], v[72:75], v[128:143]
    ds_read_b64_tr_b16 v[88:89], v12 offset:4096
    ds_read_b64_tr_b16 v[90:91], v12 offset:5120
    ds_read_b128 v[96:99], v9 offset:0
    v_mfma_f32_32x32x16_bf16 v[144:159], v[68:71], v[72:75], v[144:159]
    ds_read_b64_tr_b16 v[92:93], v13 offset:4096
    ds_read_b64_tr_b16 v[94:95], v13 offset:5120
    ds_read_b128 v[100:103], v9 offset:4096
    v_mfma_f32_32x32x16_bf16 v[160:175], v[64:67], v[76:79], v[160:175]
    ds_read_b128 v[104:107], v9 offset:8192
    ds_read_b128 v[108:111], v9 offset:12288
    v_mfma_f32_32x32x16_bf16 v[176:191], v[68:71], v[76:79], v[176:191]
    v_mfma_f32_32x32x16_bf16 v[192:207], v[64:67], v[80:83], v[192:207]
    v_mfma_f32_32x32x16_bf16 v[208:223], v[68:71], v[80:83], v[208:223]
    v_mfma_f32_32x32x16_bf16 v[224:239], v[64:67], v[84:87], v[224:239]
    v_mfma_f32_32x32x16_bf16 v[240:255], v[68:71], v[84:87], v[240:255]
    s_waitcnt lgkmcnt(0)
    v_mfma_f32_32x32x16_bf16 v[128:143], v[88:91], v[96:99], v[128:143]
    ds_read_b64_tr_b16 v[64:65], v12 offset:8192
    ds_read_b64_tr_b16 v[66:67], v12 offset:9216
    ds_read_b128 v[72:75], v10 offset:0
    v_mfma_f32_32x32x16_bf16 v[144:159], v[92:95], v[96:99], v[144:159]
    ds_read_b64_tr_b16 v[68:69], v13 offset:8192
    ds_read_b64_tr_b16 v[70:71], v13 offset:9216
    ds_read_b128 v[76:79], v10 offset:4096
    v_mfma_f32_32x32x16_bf16 v[160:175], v[88:91], v[100:103], v[160:175]
    ds_read_b128 v[80:83], v10 offset:8192
    ds_read_b128 v[84:87], v10 offset:12288
    v_mfma_f32_32x32x16_bf16 v[176:191], v[92:95], v[100:103], v[176:191]
    v_mfma_f32_32x32x16_bf16 v[192:207], v[88:91], v[104:107], v[192:207]
    v_mfma_f32_32x32x16_bf16 v[208:223], v[92:95], v[104:107], v[208:223]
    v_mfma_f32_32x32x16_bf16 v[224:239], v[88:91], v[108:111], v[224:239]
    v_mfma_f32_32x32x16_bf16 v[240:255], v[92:95], v[108:111], v[240:255]
    s_waitcnt lgkmcnt(0)
    v_mfma_f32_32x32x16_bf16 v[128:143], v[64:67], v[72:75], v[128:143]
    ds_read_b64_tr_b16 v[88:89], v12 offset:12288
    ds_read_b64_tr_b16 v[90:91], v12 offset:13312
    ds_read_b128 v[96:99], v11 offset:0
    v_mfma_f32_32x32x16_bf16 v[144:159], v[68:71], v[72:75], v[144:159]
    ds_read_b64_tr_b16 v[92:93], v13 offset:12288
    ds_read_b64_tr_b16 v[94:95], v13 offset:13312
    ds_read_b128 v[100:103], v11 offset:4096
    v_mfma_f32_32x32x16_bf16 v[160:175], v[64:67], v[76:79], v[160:175]
    ds_read_b128 v[104:107], v11 offset:8192
    ds_read_b128 v[108:111], v11 offset:12288
    v_mfma_f32_32x32x16_bf16 v[176:191], v[68:71], v[76:79], v[176:191]
    v_mfma_f32_32x32x16_bf16 v[192:207], v[64:67], v[80:83], v[192:207]
    v_mfma_f32_32x32x16_bf16 v[208:223], v[68:71], v[80:83], v[208:223]
    v_mfma_f32_32x32x16_bf16 v[224:239], v[64:67], v[84:87], v[224:239]
    v_mfma_f32_32x32x16_bf16 v[240:255], v[68:71], v[84:87], v[240:255]
    s_waitcnt lgkmcnt(0)
    s_barrier
    s_add_u32 s30, s30, 0x8000
    s_mov_b32 s28, 0x8000
    s_cmp_eq_u32 s30, 0x20000
    s_cselect_b32 s30, 0, s30
    s_cselect_b32 s28, 0xfffe8000, s28
    v_add_u32 v12, s29, v12
    v_add_u32 v13, s29, v13
    v_add_u32 v8, s28, v8
    v_add_u32 v9, s28, v9
    v_add_u32 v10, s28, v10
    v_add_u32 v11, s28, v11
    s_sub_u32 s29, 0, s29
    v_mfma_f32_32x32x16_bf16 v[128:143], v[88:91], v[96:99], v[128:143]
    ds_read_b64_tr_b16 v[64:65], v12 offset:0
    ds_read_b64_tr_b16 v[66:67], v12 offset:1024
    ds_read_b128 v[72:75], v8 offset:0
    v_mfma_f32_32x32x16_bf16 v[144:159], v[92:95], v[96:99], v[144:159]
    ds_read_b64_tr_b16 v[68:69], v13 offset:0
    ds_read_b64_tr_b16 v[70:71], v13 offset:1024
    ds_read_b128 v[76:79], v8 offset:4096
    v_mfma_f32_32x32x16_bf16 v[160:175], v[88:91], v[100:103], v[160:175]
    ds_read_b128 v[80:83], v8 offset:8192
    ds_read_b128 v[84:87], v8 offset:12288
    v_mfma_f32_32x32x16_bf16 v[176:191], v[92:95], v[100:103], v[176:191]
    v_mfma_f32_32x32x16_bf16 v[192:207], v[88:91], v[104:107], v[192:207]
    v_mfma_f32_32x32x16_bf16 v[208:223], v[92:95], v[104:107], v[208:223]
    v_mfma_f32_32x32x16_bf16 v[224:239], v[88:91], v[108:111], v[224:239]
    v_mfma_f32_32x32x16_bf16 v[240:255], v[92:95], v[108:111], v[240:255]
    s_add_u32 s31, s31, 1
    s_cmp_lt_u32 s31, 15
    s_cbranch_scc1 L_cons_loop

    s_waitcnt lgkmcnt(0)
    v_mfma_f32_32x32x16_bf16 v[128:143], v[64:67], v[72:75], v[128:143]
    ds_read_b64_tr_b16 v[88:89], v12 offset:4096
    ds_read_b64_tr_b16 v[90:91], v12 offset:5120
    ds_read_b128 v[96:99], v9 offset:0
    v_mfma_f32_32x32x16_bf16 v[144:159], v[68:71], v[72:75], v[144:159]
    ds_read_b64_tr_b16 v[92:93], v13 offset:4096
    ds_read_b64_tr_b16 v[94:95], v13 offset:5120
    ds_read_b128 v[100:103], v9 offset:4096
    v_mfma_f32_32x32x16_bf16 v[160:175], v[64:67], v[76:79], v[160:175]
    v_mfma_f32_32x32x16_bf16 v[176:191], v[68:71], v[76:79], v[176:191]
    s_waitcnt lgkmcnt(0)
    v_mfma_f32_32x32x16_bf16 v[128:143], v[88:91], v[96:99], v[128:143]
    ds_read_b64_tr_b16 v[64:65], v12 offset:8192
    ds_read_b64_tr_b16 v[66:67], v12 offset:9216
    ds_read_b128 v[72:75], v10 offset:0
    v_mfma_f32_32x32x16_bf16 v[144:159], v[92:95], v[96:99], v[144:159]
    ds_read_b64_tr_b16 v[68:69], v13 offset:8192
    ds_read_b64_tr_b16 v[70:71], v13 offset:9216
    ds_read_b128 v[76:79], v10 offset:4096
    v_mfma_f32_32x32x16_bf16 v[160:175], v[88:91], v[100:103], v[160:175]
    v_mfma_f32_32x32x16_bf16 v[176:191], v[92:95], v[100:103], v[176:191]
    s_waitcnt lgkmcnt(0)
    v_mfma_f32_32x32x16_bf16 v[128:143], v[64:67], v[72:75], v[128:143]
    ds_read_b64_tr_b16 v[88:89], v12 offset:12288
    ds_read_b64_tr_b16 v[90:91], v12 offset:13312
    ds_read_b128 v[96:99], v11 offset:0
    v_mfma_f32_32x32x16_bf16 v[144:159], v[68:71], v[72:75], v[144:159]
    ds_read_b64_tr_b16 v[92:93], v13 offset:12288
    ds_read_b64_tr_b16 v[94:95], v13 offset:13312
    ds_read_b128 v[100:103], v11 offset:4096
    v_mfma_f32_32x32x16_bf16 v[160:175], v[64:67], v[76:79], v[160:175]
    v_mfma_f32_32x32x16_bf16 v[176:191], v[68:71], v[76:79], v[176:191]
    s_waitcnt lgkmcnt(0)
    v_mfma_f32_32x32x16_bf16 v[128:143], v[88:91], v[96:99], v[128:143]
    ds_read_b64_tr_b16 v[64:65], v12 offset:0
    ds_read_b64_tr_b16 v[66:67], v12 offset:1024
    ds_read_b128 v[80:83], v8 offset:8192
    v_mfma_f32_32x32x16_bf16 v[144:159], v[92:95], v[96:99], v[144:159]
    ds_read_b64_tr_b16 v[68:69], v13 offset:0
    ds_read_b64_tr_b16 v[70:71], v13 offset:1024
    ds_read_b128 v[84:87], v8 offset:12288
    v_mfma_f32_32x32x16_bf16 v[160:175], v[88:91], v[100:103], v[160:175]
    v_mfma_f32_32x32x16_bf16 v[176:191], v[92:95], v[100:103], v[176:191]
    s_waitcnt lgkmcnt(0)
    v_mfma_f32_32x32x16_bf16 v[192:207], v[64:67], v[80:83], v[192:207]
    ds_read_b64_tr_b16 v[88:89], v12 offset:4096
    ds_read_b64_tr_b16 v[90:91], v12 offset:5120
    ds_read_b128 v[104:107], v9 offset:8192
    s_nop 7
    s_nop 3
    v_cvt_pk_bf16_f32 v32, v128, v129
    v_cvt_pk_bf16_f32 v33, v130, v131
    v_cvt_pk_bf16_f32 v34, v132, v133
    v_cvt_pk_bf16_f32 v35, v134, v135
    v_mfma_f32_32x32x16_bf16 v[208:223], v[68:71], v[80:83], v[208:223]
    ds_read_b64_tr_b16 v[92:93], v13 offset:4096
    ds_read_b64_tr_b16 v[94:95], v13 offset:5120
    ds_read_b128 v[108:111], v9 offset:12288
    v_cvt_pk_bf16_f32 v36, v136, v137
    v_cvt_pk_bf16_f32 v37, v138, v139
    v_cvt_pk_bf16_f32 v38, v140, v141
    v_cvt_pk_bf16_f32 v39, v142, v143
    ds_write_b128 v24, v[32:35] offset:0
    ds_write_b128 v25, v[36:39] offset:0
    v_mfma_f32_32x32x16_bf16 v[224:239], v[64:67], v[84:87], v[224:239]
    v_cvt_pk_bf16_f32 v40, v144, v145
    v_cvt_pk_bf16_f32 v41, v146, v147
    v_cvt_pk_bf16_f32 v42, v148, v149
    v_cvt_pk_bf16_f32 v43, v150, v151
    v_cvt_pk_bf16_f32 v44, v152, v153
    v_mfma_f32_32x32x16_bf16 v[240:255], v[68:71], v[84:87], v[240:255]
    v_cvt_pk_bf16_f32 v45, v154, v155
    v_cvt_pk_bf16_f32 v46, v156, v157
    v_cvt_pk_bf16_f32 v47, v158, v159
    ds_write_b128 v26, v[40:43] offset:0
    ds_write_b128 v27, v[44:47] offset:0
    s_waitcnt lgkmcnt(0)
    v_mfma_f32_32x32x16_bf16 v[192:207], v[88:91], v[104:107], v[192:207]
    ds_read_b64_tr_b16 v[64:65], v12 offset:8192
    ds_read_b64_tr_b16 v[66:67], v12 offset:9216
    ds_read_b128 v[80:83], v10 offset:8192
    v_cvt_pk_bf16_f32 v48, v160, v161
    v_cvt_pk_bf16_f32 v49, v162, v163
    v_cvt_pk_bf16_f32 v50, v164, v165
    v_cvt_pk_bf16_f32 v51, v166, v167
    v_cvt_pk_bf16_f32 v52, v168, v169
    v_cvt_pk_bf16_f32 v53, v170, v171
    v_mfma_f32_32x32x16_bf16 v[208:223], v[92:95], v[104:107], v[208:223]
    ds_read_b64_tr_b16 v[68:69], v13 offset:8192
    ds_read_b64_tr_b16 v[70:71], v13 offset:9216
    ds_read_b128 v[84:87], v10 offset:12288
    v_cvt_pk_bf16_f32 v54, v172, v173
    v_cvt_pk_bf16_f32 v55, v174, v175
    ds_write_b128 v24, v[48:51] offset:4096
    ds_write_b128 v25, v[52:55] offset:4096
    v_cvt_pk_bf16_f32 v56, v176, v177
    v_cvt_pk_bf16_f32 v57, v178, v179
    v_mfma_f32_32x32x16_bf16 v[224:239], v[88:91], v[108:111], v[224:239]
    v_cvt_pk_bf16_f32 v58, v180, v181
    v_cvt_pk_bf16_f32 v59, v182, v183
    v_cvt_pk_bf16_f32 v60, v184, v185
    v_cvt_pk_bf16_f32 v61, v186, v187
    v_cvt_pk_bf16_f32 v62, v188, v189
    v_cvt_pk_bf16_f32 v63, v190, v191
    v_mfma_f32_32x32x16_bf16 v[240:255], v[92:95], v[108:111], v[240:255]
    ds_write_b128 v26, v[56:59] offset:4096
    ds_write_b128 v27, v[60:63] offset:4096
    ds_read_b128 v[128:131], v28 offset:0
    ds_read_b128 v[132:135], v28 offset:1024
    ds_read_b128 v[136:139], v28 offset:2048
    ds_read_b128 v[140:143], v28 offset:3072
    s_waitcnt lgkmcnt(0)
    v_mfma_f32_32x32x16_bf16 v[192:207], v[64:67], v[80:83], v[192:207]
    ds_read_b64_tr_b16 v[88:89], v12 offset:12288
    ds_read_b64_tr_b16 v[90:91], v12 offset:13312
    ds_read_b128 v[104:107], v11 offset:8192
    ds_read_b128 v[160:163], v28 offset:4096
    ds_read_b128 v[164:167], v28 offset:5120
    ds_read_b128 v[168:171], v28 offset:6144
    v_mfma_f32_32x32x16_bf16 v[208:223], v[68:71], v[80:83], v[208:223]
    ds_read_b64_tr_b16 v[92:93], v13 offset:12288
    ds_read_b64_tr_b16 v[94:95], v13 offset:13312
    ds_read_b128 v[108:111], v11 offset:12288
    ds_read_b128 v[172:175], v28 offset:7168
    buffer_store_dwordx4 v[128:131], v29, s[24:27], s32 offen nt
    s_add_u32 s32, s32, 16384
    v_mfma_f32_32x32x16_bf16 v[224:239], v[64:67], v[84:87], v[224:239]
    buffer_store_dwordx4 v[132:135], v29, s[24:27], s32 offen nt
    s_add_u32 s32, s32, 16384
    buffer_store_dwordx4 v[136:139], v29, s[24:27], s32 offen nt
    v_mfma_f32_32x32x16_bf16 v[240:255], v[68:71], v[84:87], v[240:255]
    s_add_u32 s32, s32, 16384
    buffer_store_dwordx4 v[140:143], v29, s[24:27], s32 offen nt
    s_add_u32 s32, s32, 16384
    s_waitcnt lgkmcnt(0)
    v_mfma_f32_32x32x16_bf16 v[192:207], v[88:91], v[104:107], v[192:207]
    buffer_store_dwordx4 v[160:163], v29, s[24:27], s32 offen nt
    s_add_u32 s32, s32, 16384
    v_mfma_f32_32x32x16_bf16 v[208:223], v[92:95], v[104:107], v[208:223]
    buffer_store_dwordx4 v[164:167], v29, s[24:27], s32 offen nt
    s_add_u32 s32, s32, 16384
    v_mfma_f32_32x32x16_bf16 v[224:239], v[88:91], v[108:111], v[224:239]
    buffer_store_dwordx4 v[168:171], v29, s[24:27], s32 offen nt
    s_add_u32 s32, s32, 16384
    v_mfma_f32_32x32x16_bf16 v[240:255], v[92:95], v[108:111], v[240:255]
    buffer_store_dwordx4 v[172:175], v29, s[24:27], s32 offen nt
    s_add_u32 s32, s32, 16384
    s_nop 7
    s_nop 7
    v_cvt_pk_bf16_f32 v32, v192, v193
    v_cvt_pk_bf16_f32 v33, v194, v195
    v_cvt_pk_bf16_f32 v34, v196, v197
    v_cvt_pk_bf16_f32 v35, v198, v199
    v_cvt_pk_bf16_f32 v36, v200, v201
    v_cvt_pk_bf16_f32 v37, v202, v203
    v_cvt_pk_bf16_f32 v38, v204, v205
    v_cvt_pk_bf16_f32 v39, v206, v207
    ds_write_b128 v24, v[32:35] offset:8192
    ds_write_b128 v25, v[36:39] offset:8192
    v_cvt_pk_bf16_f32 v40, v208, v209
    v_cvt_pk_bf16_f32 v41, v210, v211
    v_cvt_pk_bf16_f32 v42, v212, v213
    v_cvt_pk_bf16_f32 v43, v214, v215
    v_cvt_pk_bf16_f32 v44, v216, v217
    v_cvt_pk_bf16_f32 v45, v218, v219
    v_cvt_pk_bf16_f32 v46, v220, v221
    v_cvt_pk_bf16_f32 v47, v222, v223
    ds_write_b128 v26, v[40:43] offset:8192
    ds_write_b128 v27, v[44:47] offset:8192
    ds_read_b128 v[192:195], v28 offset:8192
    ds_read_b128 v[196:199], v28 offset:9216
    ds_read_b128 v[200:203], v28 offset:10240
    ds_read_b128 v[204:207], v28 offset:11264
    v_cvt_pk_bf16_f32 v48, v224, v225
    v_cvt_pk_bf16_f32 v49, v226, v227
    v_cvt_pk_bf16_f32 v50, v228, v229
    v_cvt_pk_bf16_f32 v51, v230, v231
    v_cvt_pk_bf16_f32 v52, v232, v233
    v_cvt_pk_bf16_f32 v53, v234, v235
    v_cvt_pk_bf16_f32 v54, v236, v237
    v_cvt_pk_bf16_f32 v55, v238, v239
    ds_write_b128 v24, v[48:51] offset:12288
    ds_write_b128 v25, v[52:55] offset:12288
    v_cvt_pk_bf16_f32 v56, v240, v241
    v_cvt_pk_bf16_f32 v57, v242, v243
    v_cvt_pk_bf16_f32 v58, v244, v245
    v_cvt_pk_bf16_f32 v59, v246, v247
    v_cvt_pk_bf16_f32 v60, v248, v249
    v_cvt_pk_bf16_f32 v61, v250, v251
    v_cvt_pk_bf16_f32 v62, v252, v253
    v_cvt_pk_bf16_f32 v63, v254, v255
    ds_write_b128 v26, v[56:59] offset:12288
    ds_write_b128 v27, v[60:63] offset:12288
    ds_read_b128 v[224:227], v28 offset:12288
    ds_read_b128 v[228:231], v28 offset:13312
    ds_read_b128 v[232:235], v28 offset:14336
    ds_read_b128 v[236:239], v28 offset:15360
    s_waitcnt lgkmcnt(8)
    buffer_store_dwordx4 v[192:195], v29, s[24:27], s32 offen nt
    s_add_u32 s32, s32, 16384
    buffer_store_dwordx4 v[196:199], v29, s[24:27], s32 offen nt
    s_add_u32 s32, s32, 16384
    buffer_store_dwordx4 v[200:203], v29, s[24:27], s32 offen nt
    s_add_u32 s32, s32, 16384
    buffer_store_dwordx4 v[204:207], v29, s[24:27], s32 offen nt
    s_add_u32 s32, s32, 16384
    s_waitcnt lgkmcnt(0)
    buffer_store_dwordx4 v[224:227], v29, s[24:27], s32 offen nt
    s_add_u32 s32, s32, 16384
    buffer_store_dwordx4 v[228:231], v29, s[24:27], s32 offen nt
    s_add_u32 s32, s32, 16384
    buffer_store_dwordx4 v[232:235], v29, s[24:27], s32 offen nt
    s_add_u32 s32, s32, 16384
    buffer_store_dwordx4 v[236:239], v29, s[24:27], s32 offen nt
    s_add_u32 s32, s32, 16384
    s_endpgm
L_producer:
    s_sub_u32 s16, s16, 4
    s_mov_b32 s48, s4
    s_and_b32 s49, s5, 0xffff
    s_mov_b32 s50, 0x1000000
    s_mov_b32 s51, 0x00020000
    s_mov_b32 s52, s6
    s_and_b32 s53, s7, 0xffff
    s_mov_b32 s54, 0x200000
    s_mov_b32 s55, 0x00020000
    s_mov_b32 s19, 0x000f000f
    v_lshrrev_b32 v2, 3, v0
    v_lshlrev_b32 v2, 11, v2
    v_and_b32 v3, 7, v0
    v_lshrrev_b32 v4, 4, v0
    v_xor_b32 v5, v3, v4
    v_lshl_add_u32 v8, v5, 4, v2
    v_or_b32 v6, 4, v4
    v_xor_b32 v5, v3, v6
    v_lshl_add_u32 v9, v5, 4, v2
    s_lshl_b32 s28, s16, 2
    v_add_u32 v5, s28, v4
    v_and_b32 v6, 15, v0
    v_lshlrev_b32 v10, 13, v5
    v_lshl_add_u32 v10, v6, 4, v10
    v_add_u32 v11, 0x1000, v10
    v_lshrrev_b32 v7, 2, v6
    v_and_b32 v12, 3, v6
    v_lshlrev_b32 v12, 4, v12
    v_lshl_add_u32 v12, v5, 10, v12
    v_add_u32 v12, 131072, v12

    v_xor_b32 v13, 0, v7
    v_lshl_add_u32 v16, v13, 6, v12
    v_xor_b32 v13, 1, v7
    v_lshl_add_u32 v17, v13, 6, v12
    v_add_u32 v17, 256, v17
    v_xor_b32 v13, 2, v7
    v_lshl_add_u32 v18, v13, 6, v12
    v_add_u32 v18, 512, v18
    v_xor_b32 v13, 3, v7
    v_lshl_add_u32 v19, v13, 6, v12
    v_add_u32 v19, 768, v19
    s_lshl_b32 s32, s14, 19
    s_lshl_b32 s33, s16, 17
    s_add_u32 s32, s32, s33
    s_lshl_b32 s33, s15, 8
    s_lshl_b32 s35, s16, 13
    s_mov_b32 s30, 0

    buffer_load_dwordx4 v[64:67], v10, s[52:55], s33 offen
    buffer_load_dwordx4 v[68:71], v10, s[52:55], s33 offen offset:2048
    buffer_load_dwordx4 v[72:75], v11, s[52:55], s33 offen
    buffer_load_dwordx4 v[76:79], v11, s[52:55], s33 offen offset:2048
    s_add_u32 s33, s33, 0x20000
    s_add_u32 m0, s30, s35
    s_mov_b32 s37, s32
    buffer_load_dwordx4 v8, s[48:51], s37 offen lds
    s_add_u32 m0, m0, 0x400
    s_add_u32 s37, s37, 0x4000
    buffer_load_dwordx4 v9, s[48:51], s37 offen lds
    s_add_u32 m0, m0, 0x400
    s_add_u32 s37, s37, 0x4000
    buffer_load_dwordx4 v8, s[48:51], s37 offen lds
    s_add_u32 m0, m0, 0x400
    s_add_u32 s37, s37, 0x4000
    buffer_load_dwordx4 v9, s[48:51], s37 offen lds
    s_add_u32 m0, m0, 0x400
    s_add_u32 s37, s37, 0x4000
    buffer_load_dwordx4 v8, s[48:51], s37 offen lds
    s_add_u32 m0, m0, 0x400
    s_add_u32 s37, s37, 0x4000
    buffer_load_dwordx4 v9, s[48:51], s37 offen lds
    s_add_u32 m0, m0, 0x400
    s_add_u32 s37, s37, 0x4000
    buffer_load_dwordx4 v8, s[48:51], s37 offen lds
    s_add_u32 m0, m0, 0x400
    s_add_u32 s37, s37, 0x4000
    buffer_load_dwordx4 v9, s[48:51], s37 offen lds
    s_add_u32 s32, s32, 128
    s_add_u32 s30, s30, 0x8000
    s_and_b32 s30, s30, 0x1ffff
    buffer_load_dwordx4 v[80:83], v10, s[52:55], s33 offen
    buffer_load_dwordx4 v[84:87], v10, s[52:55], s33 offen offset:2048
    buffer_load_dwordx4 v[88:91], v11, s[52:55], s33 offen
    buffer_load_dwordx4 v[92:95], v11, s[52:55], s33 offen offset:2048
    s_add_u32 s33, s33, 0x20000
    s_add_u32 m0, s30, s35
    s_mov_b32 s37, s32
    buffer_load_dwordx4 v8, s[48:51], s37 offen lds
    s_add_u32 m0, m0, 0x400
    s_add_u32 s37, s37, 0x4000
    buffer_load_dwordx4 v9, s[48:51], s37 offen lds
    s_add_u32 m0, m0, 0x400
    s_add_u32 s37, s37, 0x4000
    buffer_load_dwordx4 v8, s[48:51], s37 offen lds
    s_add_u32 m0, m0, 0x400
    s_add_u32 s37, s37, 0x4000
    buffer_load_dwordx4 v9, s[48:51], s37 offen lds
    s_add_u32 m0, m0, 0x400
    s_add_u32 s37, s37, 0x4000
    buffer_load_dwordx4 v8, s[48:51], s37 offen lds
    s_add_u32 m0, m0, 0x400
    s_add_u32 s37, s37, 0x4000
    buffer_load_dwordx4 v9, s[48:51], s37 offen lds
    s_add_u32 m0, m0, 0x400
    s_add_u32 s37, s37, 0x4000
    buffer_load_dwordx4 v8, s[48:51], s37 offen lds
    s_add_u32 m0, m0, 0x400
    s_add_u32 s37, s37, 0x4000
    buffer_load_dwordx4 v9, s[48:51], s37 offen lds
    s_add_u32 s32, s32, 128
    s_add_u32 s30, s30, 0x8000
    s_and_b32 s30, s30, 0x1ffff
    s_waitcnt vmcnt(20)
    v_and_b32 v112, 0x7fff7fff, v64
    v_and_b32 v113, 0x7fff7fff, v65
    v_and_b32 v114, 0x7fff7fff, v66
    v_and_b32 v115, 0x7fff7fff, v67
    v_and_b32 v116, 0x7fff7fff, v68
    v_and_b32 v117, 0x7fff7fff, v69
    v_and_b32 v118, 0x7fff7fff, v70
    v_and_b32 v119, 0x7fff7fff, v71
    v_and_b32 v120, 0x7fff7fff, v72
    v_and_b32 v121, 0x7fff7fff, v73
    v_and_b32 v122, 0x7fff7fff, v74
    v_and_b32 v123, 0x7fff7fff, v75
    v_and_b32 v124, 0x7fff7fff, v76
    v_and_b32 v125, 0x7fff7fff, v77
    v_and_b32 v126, 0x7fff7fff, v78
    v_and_b32 v127, 0x7fff7fff, v79
    v_pk_max_u16 v128, v112, v116
    v_pk_max_u16 v129, v113, v117
    v_pk_max_u16 v130, v114, v118
    v_pk_max_u16 v131, v115, v119
    v_pk_min_u16 v132, v112, v116
    v_pk_min_u16 v133, v113, v117
    v_pk_min_u16 v134, v114, v118
    v_pk_min_u16 v135, v115, v119
    v_pk_max_u16 v136, v120, v124
    v_pk_max_u16 v137, v121, v125
    v_pk_max_u16 v138, v122, v126
    v_pk_max_u16 v139, v123, v127
    v_pk_min_u16 v140, v120, v124
    v_pk_min_u16 v141, v121, v125
    v_pk_min_u16 v142, v122, v126
    v_pk_min_u16 v143, v123, v127
    v_pk_min_u16 v128, v128, v136
    v_pk_min_u16 v129, v129, v137
    v_pk_min_u16 v130, v130, v138
    v_pk_min_u16 v131, v131, v139
    v_pk_max_u16 v132, v132, v140
    v_pk_max_u16 v133, v133, v141
    v_pk_max_u16 v134, v134, v142
    v_pk_max_u16 v135, v135, v143
    v_pk_max_u16 v128, v128, v132
    v_pk_max_u16 v129, v129, v133
    v_pk_max_u16 v130, v130, v134
    v_pk_max_u16 v131, v131, v135
    v_pk_sub_i16 v112, v112, v128
    v_pk_sub_i16 v113, v113, v129
    v_pk_sub_i16 v114, v114, v130
    v_pk_sub_i16 v115, v115, v131
    v_pk_ashrrev_i16 v112, s19, v112
    v_pk_ashrrev_i16 v113, s19, v113
    v_pk_ashrrev_i16 v114, s19, v114
    v_pk_ashrrev_i16 v115, s19, v115
    v_bfi_b32 v112, v112, 0, v64
    v_bfi_b32 v113, v113, 0, v65
    v_bfi_b32 v114, v114, 0, v66
    v_bfi_b32 v115, v115, 0, v67
    ds_write_b128 v16, v[112:115] offset:0
    v_pk_sub_i16 v116, v116, v128
    v_pk_sub_i16 v117, v117, v129
    v_pk_sub_i16 v118, v118, v130
    v_pk_sub_i16 v119, v119, v131
    v_pk_ashrrev_i16 v116, s19, v116
    v_pk_ashrrev_i16 v117, s19, v117
    v_pk_ashrrev_i16 v118, s19, v118
    v_pk_ashrrev_i16 v119, s19, v119
    v_bfi_b32 v116, v116, 0, v68
    v_bfi_b32 v117, v117, 0, v69
    v_bfi_b32 v118, v118, 0, v70
    v_bfi_b32 v119, v119, 0, v71
    ds_write_b128 v17, v[116:119] offset:0
    v_pk_sub_i16 v120, v120, v128
    v_pk_sub_i16 v121, v121, v129
    v_pk_sub_i16 v122, v122, v130
    v_pk_sub_i16 v123, v123, v131
    v_pk_ashrrev_i16 v120, s19, v120
    v_pk_ashrrev_i16 v121, s19, v121
    v_pk_ashrrev_i16 v122, s19, v122
    v_pk_ashrrev_i16 v123, s19, v123
    v_bfi_b32 v120, v120, 0, v72
    v_bfi_b32 v121, v121, 0, v73
    v_bfi_b32 v122, v122, 0, v74
    v_bfi_b32 v123, v123, 0, v75
    ds_write_b128 v18, v[120:123] offset:0
    v_pk_sub_i16 v124, v124, v128
    v_pk_sub_i16 v125, v125, v129
    v_pk_sub_i16 v126, v126, v130
    v_pk_sub_i16 v127, v127, v131
    v_pk_ashrrev_i16 v124, s19, v124
    v_pk_ashrrev_i16 v125, s19, v125
    v_pk_ashrrev_i16 v126, s19, v126
    v_pk_ashrrev_i16 v127, s19, v127
    v_bfi_b32 v124, v124, 0, v76
    v_bfi_b32 v125, v125, 0, v77
    v_bfi_b32 v126, v126, 0, v78
    v_bfi_b32 v127, v127, 0, v79
    ds_write_b128 v19, v[124:127] offset:0
    buffer_load_dwordx4 v[96:99], v10, s[52:55], s33 offen
    buffer_load_dwordx4 v[100:103], v10, s[52:55], s33 offen offset:2048
    buffer_load_dwordx4 v[104:107], v11, s[52:55], s33 offen
    buffer_load_dwordx4 v[108:111], v11, s[52:55], s33 offen offset:2048
    s_add_u32 s33, s33, 0x20000
    s_add_u32 m0, s30, s35
    s_mov_b32 s37, s32
    buffer_load_dwordx4 v8, s[48:51], s37 offen lds
    s_add_u32 m0, m0, 0x400
    s_add_u32 s37, s37, 0x4000
    buffer_load_dwordx4 v9, s[48:51], s37 offen lds
    s_add_u32 m0, m0, 0x400
    s_add_u32 s37, s37, 0x4000
    buffer_load_dwordx4 v8, s[48:51], s37 offen lds
    s_add_u32 m0, m0, 0x400
    s_add_u32 s37, s37, 0x4000
    buffer_load_dwordx4 v9, s[48:51], s37 offen lds
    s_add_u32 m0, m0, 0x400
    s_add_u32 s37, s37, 0x4000
    buffer_load_dwordx4 v8, s[48:51], s37 offen lds
    s_add_u32 m0, m0, 0x400
    s_add_u32 s37, s37, 0x4000
    buffer_load_dwordx4 v9, s[48:51], s37 offen lds
    s_add_u32 m0, m0, 0x400
    s_add_u32 s37, s37, 0x4000
    buffer_load_dwordx4 v8, s[48:51], s37 offen lds
    s_add_u32 m0, m0, 0x400
    s_add_u32 s37, s37, 0x4000
    buffer_load_dwordx4 v9, s[48:51], s37 offen lds
    s_add_u32 s32, s32, 128
    s_add_u32 s30, s30, 0x8000
    s_and_b32 s30, s30, 0x1ffff
    buffer_load_dwordx4 v[64:67], v10, s[52:55], s33 offen
    buffer_load_dwordx4 v[68:71], v10, s[52:55], s33 offen offset:2048
    buffer_load_dwordx4 v[72:75], v11, s[52:55], s33 offen
    buffer_load_dwordx4 v[76:79], v11, s[52:55], s33 offen offset:2048
    s_add_u32 s33, s33, 0x20000
    s_waitcnt vmcnt(28) lgkmcnt(0)
    s_barrier
    s_mov_b32 s31, 0
L_prod_loop:
    s_waitcnt vmcnt(24)
    s_add_u32 m0, s30, s35
    s_mov_b32 s37, s32
    buffer_load_dwordx4 v8, s[48:51], s37 offen lds
    v_and_b32 v112, 0x7fff7fff, v80
    v_and_b32 v113, 0x7fff7fff, v81
    v_and_b32 v114, 0x7fff7fff, v82
    v_and_b32 v115, 0x7fff7fff, v83
    v_and_b32 v116, 0x7fff7fff, v84
    v_and_b32 v117, 0x7fff7fff, v85
    v_and_b32 v118, 0x7fff7fff, v86
    v_and_b32 v119, 0x7fff7fff, v87
    v_and_b32 v120, 0x7fff7fff, v88
    v_and_b32 v121, 0x7fff7fff, v89
    v_and_b32 v122, 0x7fff7fff, v90
    v_and_b32 v123, 0x7fff7fff, v91
    s_add_u32 m0, m0, 0x400
    s_add_u32 s37, s37, 0x4000
    buffer_load_dwordx4 v9, s[48:51], s37 offen lds
    v_and_b32 v124, 0x7fff7fff, v92
    v_and_b32 v125, 0x7fff7fff, v93
    v_and_b32 v126, 0x7fff7fff, v94
    v_and_b32 v127, 0x7fff7fff, v95
    v_pk_max_u16 v128, v112, v116
    v_pk_max_u16 v129, v113, v117
    v_pk_max_u16 v130, v114, v118
    v_pk_max_u16 v131, v115, v119
    v_pk_min_u16 v132, v112, v116
    v_pk_min_u16 v133, v113, v117
    v_pk_min_u16 v134, v114, v118
    v_pk_min_u16 v135, v115, v119
    s_add_u32 m0, m0, 0x400
    s_add_u32 s37, s37, 0x4000
    buffer_load_dwordx4 v8, s[48:51], s37 offen lds
    v_pk_max_u16 v136, v120, v124
    v_pk_max_u16 v137, v121, v125
    v_pk_max_u16 v138, v122, v126
    v_pk_max_u16 v139, v123, v127
    v_pk_min_u16 v140, v120, v124
    v_pk_min_u16 v141, v121, v125
    v_pk_min_u16 v142, v122, v126
    v_pk_min_u16 v143, v123, v127
    v_pk_min_u16 v128, v128, v136
    v_pk_min_u16 v129, v129, v137
    v_pk_min_u16 v130, v130, v138
    v_pk_min_u16 v131, v131, v139
    s_add_u32 m0, m0, 0x400
    s_add_u32 s37, s37, 0x4000
    buffer_load_dwordx4 v9, s[48:51], s37 offen lds
    v_pk_max_u16 v132, v132, v140
    v_pk_max_u16 v133, v133, v141
    v_pk_max_u16 v134, v134, v142
    v_pk_max_u16 v135, v135, v143
    v_pk_max_u16 v128, v128, v132
    v_pk_max_u16 v129, v129, v133
    v_pk_max_u16 v130, v130, v134
    v_pk_max_u16 v131, v131, v135
    v_pk_sub_i16 v112, v112, v128
    v_pk_sub_i16 v113, v113, v129
    v_pk_sub_i16 v114, v114, v130
    v_pk_sub_i16 v115, v115, v131
    s_add_u32 m0, m0, 0x400
    s_add_u32 s37, s37, 0x4000
    buffer_load_dwordx4 v8, s[48:51], s37 offen lds
    v_pk_ashrrev_i16 v112, s19, v112
    v_pk_ashrrev_i16 v113, s19, v113
    v_pk_ashrrev_i16 v114, s19, v114
    v_pk_ashrrev_i16 v115, s19, v115
    v_bfi_b32 v112, v112, 0, v80
    v_bfi_b32 v113, v113, 0, v81
    v_bfi_b32 v114, v114, 0, v82
    v_bfi_b32 v115, v115, 0, v83
    ds_write_b128 v16, v[112:115] offset:16384
    v_pk_sub_i16 v116, v116, v128
    v_pk_sub_i16 v117, v117, v129
    v_pk_sub_i16 v118, v118, v130
    s_add_u32 m0, m0, 0x400
    s_add_u32 s37, s37, 0x4000
    buffer_load_dwordx4 v9, s[48:51], s37 offen lds
    v_pk_sub_i16 v119, v119, v131
    v_pk_ashrrev_i16 v116, s19, v116
    v_pk_ashrrev_i16 v117, s19, v117
    v_pk_ashrrev_i16 v118, s19, v118
    v_pk_ashrrev_i16 v119, s19, v119
    v_bfi_b32 v116, v116, 0, v84
    v_bfi_b32 v117, v117, 0, v85
    v_bfi_b32 v118, v118, 0, v86
    v_bfi_b32 v119, v119, 0, v87
    ds_write_b128 v17, v[116:119] offset:16384
    v_pk_sub_i16 v120, v120, v128
    v_pk_sub_i16 v121, v121, v129
    s_add_u32 m0, m0, 0x400
    s_add_u32 s37, s37, 0x4000
    buffer_load_dwordx4 v8, s[48:51], s37 offen lds
    v_pk_sub_i16 v122, v122, v130
    v_pk_sub_i16 v123, v123, v131
    v_pk_ashrrev_i16 v120, s19, v120
    v_pk_ashrrev_i16 v121, s19, v121
    v_pk_ashrrev_i16 v122, s19, v122
    v_pk_ashrrev_i16 v123, s19, v123
    v_bfi_b32 v120, v120, 0, v88
    v_bfi_b32 v121, v121, 0, v89
    v_bfi_b32 v122, v122, 0, v90
    v_bfi_b32 v123, v123, 0, v91
    ds_write_b128 v18, v[120:123] offset:16384
    v_pk_sub_i16 v124, v124, v128
    s_add_u32 m0, m0, 0x400
    s_add_u32 s37, s37, 0x4000
    buffer_load_dwordx4 v9, s[48:51], s37 offen lds
    s_add_u32 s32, s32, 128
    s_add_u32 s30, s30, 0x8000
    s_and_b32 s30, s30, 0x1ffff
    v_pk_sub_i16 v125, v125, v129
    v_pk_sub_i16 v126, v126, v130
    v_pk_sub_i16 v127, v127, v131
    v_pk_ashrrev_i16 v124, s19, v124
    v_pk_ashrrev_i16 v125, s19, v125
    v_pk_ashrrev_i16 v126, s19, v126
    v_pk_ashrrev_i16 v127, s19, v127
    v_bfi_b32 v124, v124, 0, v92
    v_bfi_b32 v125, v125, 0, v93
    v_bfi_b32 v126, v126, 0, v94
    v_bfi_b32 v127, v127, 0, v95
    ds_write_b128 v19, v[124:127] offset:16384
    buffer_load_dwordx4 v[80:83], v10, s[52:55], s33 offen
    buffer_load_dwordx4 v[84:87], v10, s[52:55], s33 offen offset:2048
    buffer_load_dwordx4 v[88:91], v11, s[52:55], s33 offen
    buffer_load_dwordx4 v[92:95], v11, s[52:55], s33 offen offset:2048
    s_add_u32 s33, s33, 0x20000
    s_waitcnt vmcnt(28) lgkmcnt(0)
    s_barrier
    s_waitcnt vmcnt(24)
    s_add_u32 m0, s30, s35
    s_mov_b32 s37, s32
    buffer_load_dwordx4 v8, s[48:51], s37 offen lds
    v_and_b32 v112, 0x7fff7fff, v96
    v_and_b32 v113, 0x7fff7fff, v97
    v_and_b32 v114, 0x7fff7fff, v98
    v_and_b32 v115, 0x7fff7fff, v99
    v_and_b32 v116, 0x7fff7fff, v100
    v_and_b32 v117, 0x7fff7fff, v101
    v_and_b32 v118, 0x7fff7fff, v102
    v_and_b32 v119, 0x7fff7fff, v103
    v_and_b32 v120, 0x7fff7fff, v104
    v_and_b32 v121, 0x7fff7fff, v105
    v_and_b32 v122, 0x7fff7fff, v106
    v_and_b32 v123, 0x7fff7fff, v107
    s_add_u32 m0, m0, 0x400
    s_add_u32 s37, s37, 0x4000
    buffer_load_dwordx4 v9, s[48:51], s37 offen lds
    v_and_b32 v124, 0x7fff7fff, v108
    v_and_b32 v125, 0x7fff7fff, v109
    v_and_b32 v126, 0x7fff7fff, v110
    v_and_b32 v127, 0x7fff7fff, v111
    v_pk_max_u16 v128, v112, v116
    v_pk_max_u16 v129, v113, v117
    v_pk_max_u16 v130, v114, v118
    v_pk_max_u16 v131, v115, v119
    v_pk_min_u16 v132, v112, v116
    v_pk_min_u16 v133, v113, v117
    v_pk_min_u16 v134, v114, v118
    v_pk_min_u16 v135, v115, v119
    s_add_u32 m0, m0, 0x400
    s_add_u32 s37, s37, 0x4000
    buffer_load_dwordx4 v8, s[48:51], s37 offen lds
    v_pk_max_u16 v136, v120, v124
    v_pk_max_u16 v137, v121, v125
    v_pk_max_u16 v138, v122, v126
    v_pk_max_u16 v139, v123, v127
    v_pk_min_u16 v140, v120, v124
    v_pk_min_u16 v141, v121, v125
    v_pk_min_u16 v142, v122, v126
    v_pk_min_u16 v143, v123, v127
    v_pk_min_u16 v128, v128, v136
    v_pk_min_u16 v129, v129, v137
    v_pk_min_u16 v130, v130, v138
    v_pk_min_u16 v131, v131, v139
    s_add_u32 m0, m0, 0x400
    s_add_u32 s37, s37, 0x4000
    buffer_load_dwordx4 v9, s[48:51], s37 offen lds
    v_pk_max_u16 v132, v132, v140
    v_pk_max_u16 v133, v133, v141
    v_pk_max_u16 v134, v134, v142
    v_pk_max_u16 v135, v135, v143
    v_pk_max_u16 v128, v128, v132
    v_pk_max_u16 v129, v129, v133
    v_pk_max_u16 v130, v130, v134
    v_pk_max_u16 v131, v131, v135
    v_pk_sub_i16 v112, v112, v128
    v_pk_sub_i16 v113, v113, v129
    v_pk_sub_i16 v114, v114, v130
    v_pk_sub_i16 v115, v115, v131
    s_add_u32 m0, m0, 0x400
    s_add_u32 s37, s37, 0x4000
    buffer_load_dwordx4 v8, s[48:51], s37 offen lds
    v_pk_ashrrev_i16 v112, s19, v112
    v_pk_ashrrev_i16 v113, s19, v113
    v_pk_ashrrev_i16 v114, s19, v114
    v_pk_ashrrev_i16 v115, s19, v115
    v_bfi_b32 v112, v112, 0, v96
    v_bfi_b32 v113, v113, 0, v97
    v_bfi_b32 v114, v114, 0, v98
    v_bfi_b32 v115, v115, 0, v99
    ds_write_b128 v16, v[112:115] offset:0
    v_pk_sub_i16 v116, v116, v128
    v_pk_sub_i16 v117, v117, v129
    v_pk_sub_i16 v118, v118, v130
    s_add_u32 m0, m0, 0x400
    s_add_u32 s37, s37, 0x4000
    buffer_load_dwordx4 v9, s[48:51], s37 offen lds
    v_pk_sub_i16 v119, v119, v131
    v_pk_ashrrev_i16 v116, s19, v116
    v_pk_ashrrev_i16 v117, s19, v117
    v_pk_ashrrev_i16 v118, s19, v118
    v_pk_ashrrev_i16 v119, s19, v119
    v_bfi_b32 v116, v116, 0, v100
    v_bfi_b32 v117, v117, 0, v101
    v_bfi_b32 v118, v118, 0, v102
    v_bfi_b32 v119, v119, 0, v103
    ds_write_b128 v17, v[116:119] offset:0
    v_pk_sub_i16 v120, v120, v128
    v_pk_sub_i16 v121, v121, v129
    s_add_u32 m0, m0, 0x400
    s_add_u32 s37, s37, 0x4000
    buffer_load_dwordx4 v8, s[48:51], s37 offen lds
    v_pk_sub_i16 v122, v122, v130
    v_pk_sub_i16 v123, v123, v131
    v_pk_ashrrev_i16 v120, s19, v120
    v_pk_ashrrev_i16 v121, s19, v121
    v_pk_ashrrev_i16 v122, s19, v122
    v_pk_ashrrev_i16 v123, s19, v123
    v_bfi_b32 v120, v120, 0, v104
    v_bfi_b32 v121, v121, 0, v105
    v_bfi_b32 v122, v122, 0, v106
    v_bfi_b32 v123, v123, 0, v107
    ds_write_b128 v18, v[120:123] offset:0
    v_pk_sub_i16 v124, v124, v128
    s_add_u32 m0, m0, 0x400
    s_add_u32 s37, s37, 0x4000
    buffer_load_dwordx4 v9, s[48:51], s37 offen lds
    s_add_u32 s32, s32, 128
    s_add_u32 s30, s30, 0x8000
    s_and_b32 s30, s30, 0x1ffff
    v_pk_sub_i16 v125, v125, v129
    v_pk_sub_i16 v126, v126, v130
    v_pk_sub_i16 v127, v127, v131
    v_pk_ashrrev_i16 v124, s19, v124
    v_pk_ashrrev_i16 v125, s19, v125
    v_pk_ashrrev_i16 v126, s19, v126
    v_pk_ashrrev_i16 v127, s19, v127
    v_bfi_b32 v124, v124, 0, v108
    v_bfi_b32 v125, v125, 0, v109
    v_bfi_b32 v126, v126, 0, v110
    v_bfi_b32 v127, v127, 0, v111
    ds_write_b128 v19, v[124:127] offset:0
    buffer_load_dwordx4 v[96:99], v10, s[52:55], s33 offen
    buffer_load_dwordx4 v[100:103], v10, s[52:55], s33 offen offset:2048
    buffer_load_dwordx4 v[104:107], v11, s[52:55], s33 offen
    buffer_load_dwordx4 v[108:111], v11, s[52:55], s33 offen offset:2048
    s_add_u32 s33, s33, 0x20000
    s_waitcnt vmcnt(28) lgkmcnt(0)
    s_barrier
    s_waitcnt vmcnt(24)
    s_add_u32 m0, s30, s35
    s_mov_b32 s37, s32
    buffer_load_dwordx4 v8, s[48:51], s37 offen lds
    v_and_b32 v112, 0x7fff7fff, v64
    v_and_b32 v113, 0x7fff7fff, v65
    v_and_b32 v114, 0x7fff7fff, v66
    v_and_b32 v115, 0x7fff7fff, v67
    v_and_b32 v116, 0x7fff7fff, v68
    v_and_b32 v117, 0x7fff7fff, v69
    v_and_b32 v118, 0x7fff7fff, v70
    v_and_b32 v119, 0x7fff7fff, v71
    v_and_b32 v120, 0x7fff7fff, v72
    v_and_b32 v121, 0x7fff7fff, v73
    v_and_b32 v122, 0x7fff7fff, v74
    v_and_b32 v123, 0x7fff7fff, v75
    s_add_u32 m0, m0, 0x400
    s_add_u32 s37, s37, 0x4000
    buffer_load_dwordx4 v9, s[48:51], s37 offen lds
    v_and_b32 v124, 0x7fff7fff, v76
    v_and_b32 v125, 0x7fff7fff, v77
    v_and_b32 v126, 0x7fff7fff, v78
    v_and_b32 v127, 0x7fff7fff, v79
    v_pk_max_u16 v128, v112, v116
    v_pk_max_u16 v129, v113, v117
    v_pk_max_u16 v130, v114, v118
    v_pk_max_u16 v131, v115, v119
    v_pk_min_u16 v132, v112, v116
    v_pk_min_u16 v133, v113, v117
    v_pk_min_u16 v134, v114, v118
    v_pk_min_u16 v135, v115, v119
    s_add_u32 m0, m0, 0x400
    s_add_u32 s37, s37, 0x4000
    buffer_load_dwordx4 v8, s[48:51], s37 offen lds
    v_pk_max_u16 v136, v120, v124
    v_pk_max_u16 v137, v121, v125
    v_pk_max_u16 v138, v122, v126
    v_pk_max_u16 v139, v123, v127
    v_pk_min_u16 v140, v120, v124
    v_pk_min_u16 v141, v121, v125
    v_pk_min_u16 v142, v122, v126
    v_pk_min_u16 v143, v123, v127
    v_pk_min_u16 v128, v128, v136
    v_pk_min_u16 v129, v129, v137
    v_pk_min_u16 v130, v130, v138
    v_pk_min_u16 v131, v131, v139
    s_add_u32 m0, m0, 0x400
    s_add_u32 s37, s37, 0x4000
    buffer_load_dwordx4 v9, s[48:51], s37 offen lds
    v_pk_max_u16 v132, v132, v140
    v_pk_max_u16 v133, v133, v141
    v_pk_max_u16 v134, v134, v142
    v_pk_max_u16 v135, v135, v143
    v_pk_max_u16 v128, v128, v132
    v_pk_max_u16 v129, v129, v133
    v_pk_max_u16 v130, v130, v134
    v_pk_max_u16 v131, v131, v135
    v_pk_sub_i16 v112, v112, v128
    v_pk_sub_i16 v113, v113, v129
    v_pk_sub_i16 v114, v114, v130
    v_pk_sub_i16 v115, v115, v131
    s_add_u32 m0, m0, 0x400
    s_add_u32 s37, s37, 0x4000
    buffer_load_dwordx4 v8, s[48:51], s37 offen lds
    v_pk_ashrrev_i16 v112, s19, v112
    v_pk_ashrrev_i16 v113, s19, v113
    v_pk_ashrrev_i16 v114, s19, v114
    v_pk_ashrrev_i16 v115, s19, v115
    v_bfi_b32 v112, v112, 0, v64
    v_bfi_b32 v113, v113, 0, v65
    v_bfi_b32 v114, v114, 0, v66
    v_bfi_b32 v115, v115, 0, v67
    ds_write_b128 v16, v[112:115] offset:16384
    v_pk_sub_i16 v116, v116, v128
    v_pk_sub_i16 v117, v117, v129
    v_pk_sub_i16 v118, v118, v130
    s_add_u32 m0, m0, 0x400
    s_add_u32 s37, s37, 0x4000
    buffer_load_dwordx4 v9, s[48:51], s37 offen lds
    v_pk_sub_i16 v119, v119, v131
    v_pk_ashrrev_i16 v116, s19, v116
    v_pk_ashrrev_i16 v117, s19, v117
    v_pk_ashrrev_i16 v118, s19, v118
    v_pk_ashrrev_i16 v119, s19, v119
    v_bfi_b32 v116, v116, 0, v68
    v_bfi_b32 v117, v117, 0, v69
    v_bfi_b32 v118, v118, 0, v70
    v_bfi_b32 v119, v119, 0, v71
    ds_write_b128 v17, v[116:119] offset:16384
    v_pk_sub_i16 v120, v120, v128
    v_pk_sub_i16 v121, v121, v129
    s_add_u32 m0, m0, 0x400
    s_add_u32 s37, s37, 0x4000
    buffer_load_dwordx4 v8, s[48:51], s37 offen lds
    v_pk_sub_i16 v122, v122, v130
    v_pk_sub_i16 v123, v123, v131
    v_pk_ashrrev_i16 v120, s19, v120
    v_pk_ashrrev_i16 v121, s19, v121
    v_pk_ashrrev_i16 v122, s19, v122
    v_pk_ashrrev_i16 v123, s19, v123
    v_bfi_b32 v120, v120, 0, v72
    v_bfi_b32 v121, v121, 0, v73
    v_bfi_b32 v122, v122, 0, v74
    v_bfi_b32 v123, v123, 0, v75
    ds_write_b128 v18, v[120:123] offset:16384
    v_pk_sub_i16 v124, v124, v128
    s_add_u32 m0, m0, 0x400
    s_add_u32 s37, s37, 0x4000
    buffer_load_dwordx4 v9, s[48:51], s37 offen lds
    s_add_u32 s32, s32, 128
    s_add_u32 s30, s30, 0x8000
    s_and_b32 s30, s30, 0x1ffff
    v_pk_sub_i16 v125, v125, v129
    v_pk_sub_i16 v126, v126, v130
    v_pk_sub_i16 v127, v127, v131
    v_pk_ashrrev_i16 v124, s19, v124
    v_pk_ashrrev_i16 v125, s19, v125
    v_pk_ashrrev_i16 v126, s19, v126
    v_pk_ashrrev_i16 v127, s19, v127
    v_bfi_b32 v124, v124, 0, v76
    v_bfi_b32 v125, v125, 0, v77
    v_bfi_b32 v126, v126, 0, v78
    v_bfi_b32 v127, v127, 0, v79
    ds_write_b128 v19, v[124:127] offset:16384
    buffer_load_dwordx4 v[64:67], v10, s[52:55], s33 offen
    buffer_load_dwordx4 v[68:71], v10, s[52:55], s33 offen offset:2048
    buffer_load_dwordx4 v[72:75], v11, s[52:55], s33 offen
    buffer_load_dwordx4 v[76:79], v11, s[52:55], s33 offen offset:2048
    s_add_u32 s33, s33, 0x20000
    s_waitcnt vmcnt(28) lgkmcnt(0)
    s_barrier
    s_waitcnt vmcnt(24)
    s_add_u32 m0, s30, s35
    s_mov_b32 s37, s32
    buffer_load_dwordx4 v8, s[48:51], s37 offen lds
    v_and_b32 v112, 0x7fff7fff, v80
    v_and_b32 v113, 0x7fff7fff, v81
    v_and_b32 v114, 0x7fff7fff, v82
    v_and_b32 v115, 0x7fff7fff, v83
    v_and_b32 v116, 0x7fff7fff, v84
    v_and_b32 v117, 0x7fff7fff, v85
    v_and_b32 v118, 0x7fff7fff, v86
    v_and_b32 v119, 0x7fff7fff, v87
    v_and_b32 v120, 0x7fff7fff, v88
    v_and_b32 v121, 0x7fff7fff, v89
    v_and_b32 v122, 0x7fff7fff, v90
    v_and_b32 v123, 0x7fff7fff, v91
    s_add_u32 m0, m0, 0x400
    s_add_u32 s37, s37, 0x4000
    buffer_load_dwordx4 v9, s[48:51], s37 offen lds
    v_and_b32 v124, 0x7fff7fff, v92
    v_and_b32 v125, 0x7fff7fff, v93
    v_and_b32 v126, 0x7fff7fff, v94
    v_and_b32 v127, 0x7fff7fff, v95
    v_pk_max_u16 v128, v112, v116
    v_pk_max_u16 v129, v113, v117
    v_pk_max_u16 v130, v114, v118
    v_pk_max_u16 v131, v115, v119
    v_pk_min_u16 v132, v112, v116
    v_pk_min_u16 v133, v113, v117
    v_pk_min_u16 v134, v114, v118
    v_pk_min_u16 v135, v115, v119
    s_add_u32 m0, m0, 0x400
    s_add_u32 s37, s37, 0x4000
    buffer_load_dwordx4 v8, s[48:51], s37 offen lds
    v_pk_max_u16 v136, v120, v124
    v_pk_max_u16 v137, v121, v125
    v_pk_max_u16 v138, v122, v126
    v_pk_max_u16 v139, v123, v127
    v_pk_min_u16 v140, v120, v124
    v_pk_min_u16 v141, v121, v125
    v_pk_min_u16 v142, v122, v126
    v_pk_min_u16 v143, v123, v127
    v_pk_min_u16 v128, v128, v136
    v_pk_min_u16 v129, v129, v137
    v_pk_min_u16 v130, v130, v138
    v_pk_min_u16 v131, v131, v139
    s_add_u32 m0, m0, 0x400
    s_add_u32 s37, s37, 0x4000
    buffer_load_dwordx4 v9, s[48:51], s37 offen lds
    v_pk_max_u16 v132, v132, v140
    v_pk_max_u16 v133, v133, v141
    v_pk_max_u16 v134, v134, v142
    v_pk_max_u16 v135, v135, v143
    v_pk_max_u16 v128, v128, v132
    v_pk_max_u16 v129, v129, v133
    v_pk_max_u16 v130, v130, v134
    v_pk_max_u16 v131, v131, v135
    v_pk_sub_i16 v112, v112, v128
    v_pk_sub_i16 v113, v113, v129
    v_pk_sub_i16 v114, v114, v130
    v_pk_sub_i16 v115, v115, v131
    s_add_u32 m0, m0, 0x400
    s_add_u32 s37, s37, 0x4000
    buffer_load_dwordx4 v8, s[48:51], s37 offen lds
    v_pk_ashrrev_i16 v112, s19, v112
    v_pk_ashrrev_i16 v113, s19, v113
    v_pk_ashrrev_i16 v114, s19, v114
    v_pk_ashrrev_i16 v115, s19, v115
    v_bfi_b32 v112, v112, 0, v80
    v_bfi_b32 v113, v113, 0, v81
    v_bfi_b32 v114, v114, 0, v82
    v_bfi_b32 v115, v115, 0, v83
    ds_write_b128 v16, v[112:115] offset:0
    v_pk_sub_i16 v116, v116, v128
    v_pk_sub_i16 v117, v117, v129
    v_pk_sub_i16 v118, v118, v130
    s_add_u32 m0, m0, 0x400
    s_add_u32 s37, s37, 0x4000
    buffer_load_dwordx4 v9, s[48:51], s37 offen lds
    v_pk_sub_i16 v119, v119, v131
    v_pk_ashrrev_i16 v116, s19, v116
    v_pk_ashrrev_i16 v117, s19, v117
    v_pk_ashrrev_i16 v118, s19, v118
    v_pk_ashrrev_i16 v119, s19, v119
    v_bfi_b32 v116, v116, 0, v84
    v_bfi_b32 v117, v117, 0, v85
    v_bfi_b32 v118, v118, 0, v86
    v_bfi_b32 v119, v119, 0, v87
    ds_write_b128 v17, v[116:119] offset:0
    v_pk_sub_i16 v120, v120, v128
    v_pk_sub_i16 v121, v121, v129
    s_add_u32 m0, m0, 0x400
    s_add_u32 s37, s37, 0x4000
    buffer_load_dwordx4 v8, s[48:51], s37 offen lds
    v_pk_sub_i16 v122, v122, v130
    v_pk_sub_i16 v123, v123, v131
    v_pk_ashrrev_i16 v120, s19, v120
    v_pk_ashrrev_i16 v121, s19, v121
    v_pk_ashrrev_i16 v122, s19, v122
    v_pk_ashrrev_i16 v123, s19, v123
    v_bfi_b32 v120, v120, 0, v88
    v_bfi_b32 v121, v121, 0, v89
    v_bfi_b32 v122, v122, 0, v90
    v_bfi_b32 v123, v123, 0, v91
    ds_write_b128 v18, v[120:123] offset:0
    v_pk_sub_i16 v124, v124, v128
    s_add_u32 m0, m0, 0x400
    s_add_u32 s37, s37, 0x4000
    buffer_load_dwordx4 v9, s[48:51], s37 offen lds
    s_add_u32 s32, s32, 128
    s_add_u32 s30, s30, 0x8000
    s_and_b32 s30, s30, 0x1ffff
    v_pk_sub_i16 v125, v125, v129
    v_pk_sub_i16 v126, v126, v130
    v_pk_sub_i16 v127, v127, v131
    v_pk_ashrrev_i16 v124, s19, v124
    v_pk_ashrrev_i16 v125, s19, v125
    v_pk_ashrrev_i16 v126, s19, v126
    v_pk_ashrrev_i16 v127, s19, v127
    v_bfi_b32 v124, v124, 0, v92
    v_bfi_b32 v125, v125, 0, v93
    v_bfi_b32 v126, v126, 0, v94
    v_bfi_b32 v127, v127, 0, v95
    ds_write_b128 v19, v[124:127] offset:0
    buffer_load_dwordx4 v[80:83], v10, s[52:55], s33 offen
    buffer_load_dwordx4 v[84:87], v10, s[52:55], s33 offen offset:2048
    buffer_load_dwordx4 v[88:91], v11, s[52:55], s33 offen
    buffer_load_dwordx4 v[92:95], v11, s[52:55], s33 offen offset:2048
    s_add_u32 s33, s33, 0x20000
    s_waitcnt vmcnt(28) lgkmcnt(0)
    s_barrier
    s_waitcnt vmcnt(24)
    s_add_u32 m0, s30, s35
    s_mov_b32 s37, s32
    buffer_load_dwordx4 v8, s[48:51], s37 offen lds
    v_and_b32 v112, 0x7fff7fff, v96
    v_and_b32 v113, 0x7fff7fff, v97
    v_and_b32 v114, 0x7fff7fff, v98
    v_and_b32 v115, 0x7fff7fff, v99
    v_and_b32 v116, 0x7fff7fff, v100
    v_and_b32 v117, 0x7fff7fff, v101
    v_and_b32 v118, 0x7fff7fff, v102
    v_and_b32 v119, 0x7fff7fff, v103
    v_and_b32 v120, 0x7fff7fff, v104
    v_and_b32 v121, 0x7fff7fff, v105
    v_and_b32 v122, 0x7fff7fff, v106
    v_and_b32 v123, 0x7fff7fff, v107
    s_add_u32 m0, m0, 0x400
    s_add_u32 s37, s37, 0x4000
    buffer_load_dwordx4 v9, s[48:51], s37 offen lds
    v_and_b32 v124, 0x7fff7fff, v108
    v_and_b32 v125, 0x7fff7fff, v109
    v_and_b32 v126, 0x7fff7fff, v110
    v_and_b32 v127, 0x7fff7fff, v111
    v_pk_max_u16 v128, v112, v116
    v_pk_max_u16 v129, v113, v117
    v_pk_max_u16 v130, v114, v118
    v_pk_max_u16 v131, v115, v119
    v_pk_min_u16 v132, v112, v116
    v_pk_min_u16 v133, v113, v117
    v_pk_min_u16 v134, v114, v118
    v_pk_min_u16 v135, v115, v119
    s_add_u32 m0, m0, 0x400
    s_add_u32 s37, s37, 0x4000
    buffer_load_dwordx4 v8, s[48:51], s37 offen lds
    v_pk_max_u16 v136, v120, v124
    v_pk_max_u16 v137, v121, v125
    v_pk_max_u16 v138, v122, v126
    v_pk_max_u16 v139, v123, v127
    v_pk_min_u16 v140, v120, v124
    v_pk_min_u16 v141, v121, v125
    v_pk_min_u16 v142, v122, v126
    v_pk_min_u16 v143, v123, v127
    v_pk_min_u16 v128, v128, v136
    v_pk_min_u16 v129, v129, v137
    v_pk_min_u16 v130, v130, v138
    v_pk_min_u16 v131, v131, v139
    s_add_u32 m0, m0, 0x400
    s_add_u32 s37, s37, 0x4000
    buffer_load_dwordx4 v9, s[48:51], s37 offen lds
    v_pk_max_u16 v132, v132, v140
    v_pk_max_u16 v133, v133, v141
    v_pk_max_u16 v134, v134, v142
    v_pk_max_u16 v135, v135, v143
    v_pk_max_u16 v128, v128, v132
    v_pk_max_u16 v129, v129, v133
    v_pk_max_u16 v130, v130, v134
    v_pk_max_u16 v131, v131, v135
    v_pk_sub_i16 v112, v112, v128
    v_pk_sub_i16 v113, v113, v129
    v_pk_sub_i16 v114, v114, v130
    v_pk_sub_i16 v115, v115, v131
    s_add_u32 m0, m0, 0x400
    s_add_u32 s37, s37, 0x4000
    buffer_load_dwordx4 v8, s[48:51], s37 offen lds
    v_pk_ashrrev_i16 v112, s19, v112
    v_pk_ashrrev_i16 v113, s19, v113
    v_pk_ashrrev_i16 v114, s19, v114
    v_pk_ashrrev_i16 v115, s19, v115
    v_bfi_b32 v112, v112, 0, v96
    v_bfi_b32 v113, v113, 0, v97
    v_bfi_b32 v114, v114, 0, v98
    v_bfi_b32 v115, v115, 0, v99
    ds_write_b128 v16, v[112:115] offset:16384
    v_pk_sub_i16 v116, v116, v128
    v_pk_sub_i16 v117, v117, v129
    v_pk_sub_i16 v118, v118, v130
    s_add_u32 m0, m0, 0x400
    s_add_u32 s37, s37, 0x4000
    buffer_load_dwordx4 v9, s[48:51], s37 offen lds
    v_pk_sub_i16 v119, v119, v131
    v_pk_ashrrev_i16 v116, s19, v116
    v_pk_ashrrev_i16 v117, s19, v117
    v_pk_ashrrev_i16 v118, s19, v118
    v_pk_ashrrev_i16 v119, s19, v119
    v_bfi_b32 v116, v116, 0, v100
    v_bfi_b32 v117, v117, 0, v101
    v_bfi_b32 v118, v118, 0, v102
    v_bfi_b32 v119, v119, 0, v103
    ds_write_b128 v17, v[116:119] offset:16384
    v_pk_sub_i16 v120, v120, v128
    v_pk_sub_i16 v121, v121, v129
    s_add_u32 m0, m0, 0x400
    s_add_u32 s37, s37, 0x4000
    buffer_load_dwordx4 v8, s[48:51], s37 offen lds
    v_pk_sub_i16 v122, v122, v130
    v_pk_sub_i16 v123, v123, v131
    v_pk_ashrrev_i16 v120, s19, v120
    v_pk_ashrrev_i16 v121, s19, v121
    v_pk_ashrrev_i16 v122, s19, v122
    v_pk_ashrrev_i16 v123, s19, v123
    v_bfi_b32 v120, v120, 0, v104
    v_bfi_b32 v121, v121, 0, v105
    v_bfi_b32 v122, v122, 0, v106
    v_bfi_b32 v123, v123, 0, v107
    ds_write_b128 v18, v[120:123] offset:16384
    v_pk_sub_i16 v124, v124, v128
    s_add_u32 m0, m0, 0x400
    s_add_u32 s37, s37, 0x4000
    buffer_load_dwordx4 v9, s[48:51], s37 offen lds
    s_add_u32 s32, s32, 128
    s_add_u32 s30, s30, 0x8000
    s_and_b32 s30, s30, 0x1ffff
    v_pk_sub_i16 v125, v125, v129
    v_pk_sub_i16 v126, v126, v130
    v_pk_sub_i16 v127, v127, v131
    v_pk_ashrrev_i16 v124, s19, v124
    v_pk_ashrrev_i16 v125, s19, v125
    v_pk_ashrrev_i16 v126, s19, v126
    v_pk_ashrrev_i16 v127, s19, v127
    v_bfi_b32 v124, v124, 0, v108
    v_bfi_b32 v125, v125, 0, v109
    v_bfi_b32 v126, v126, 0, v110
    v_bfi_b32 v127, v127, 0, v111
    ds_write_b128 v19, v[124:127] offset:16384
    buffer_load_dwordx4 v[96:99], v10, s[52:55], s33 offen
    buffer_load_dwordx4 v[100:103], v10, s[52:55], s33 offen offset:2048
    buffer_load_dwordx4 v[104:107], v11, s[52:55], s33 offen
    buffer_load_dwordx4 v[108:111], v11, s[52:55], s33 offen offset:2048
    s_add_u32 s33, s33, 0x20000
    s_waitcnt vmcnt(28) lgkmcnt(0)
    s_barrier
    s_waitcnt vmcnt(24)
    s_add_u32 m0, s30, s35
    s_mov_b32 s37, s32
    buffer_load_dwordx4 v8, s[48:51], s37 offen lds
    v_and_b32 v112, 0x7fff7fff, v64
    v_and_b32 v113, 0x7fff7fff, v65
    v_and_b32 v114, 0x7fff7fff, v66
    v_and_b32 v115, 0x7fff7fff, v67
    v_and_b32 v116, 0x7fff7fff, v68
    v_and_b32 v117, 0x7fff7fff, v69
    v_and_b32 v118, 0x7fff7fff, v70
    v_and_b32 v119, 0x7fff7fff, v71
    v_and_b32 v120, 0x7fff7fff, v72
    v_and_b32 v121, 0x7fff7fff, v73
    v_and_b32 v122, 0x7fff7fff, v74
    v_and_b32 v123, 0x7fff7fff, v75
    s_add_u32 m0, m0, 0x400
    s_add_u32 s37, s37, 0x4000
    buffer_load_dwordx4 v9, s[48:51], s37 offen lds
    v_and_b32 v124, 0x7fff7fff, v76
    v_and_b32 v125, 0x7fff7fff, v77
    v_and_b32 v126, 0x7fff7fff, v78
    v_and_b32 v127, 0x7fff7fff, v79
    v_pk_max_u16 v128, v112, v116
    v_pk_max_u16 v129, v113, v117
    v_pk_max_u16 v130, v114, v118
    v_pk_max_u16 v131, v115, v119
    v_pk_min_u16 v132, v112, v116
    v_pk_min_u16 v133, v113, v117
    v_pk_min_u16 v134, v114, v118
    v_pk_min_u16 v135, v115, v119
    s_add_u32 m0, m0, 0x400
    s_add_u32 s37, s37, 0x4000
    buffer_load_dwordx4 v8, s[48:51], s37 offen lds
    v_pk_max_u16 v136, v120, v124
    v_pk_max_u16 v137, v121, v125
    v_pk_max_u16 v138, v122, v126
    v_pk_max_u16 v139, v123, v127
    v_pk_min_u16 v140, v120, v124
    v_pk_min_u16 v141, v121, v125
    v_pk_min_u16 v142, v122, v126
    v_pk_min_u16 v143, v123, v127
    v_pk_min_u16 v128, v128, v136
    v_pk_min_u16 v129, v129, v137
    v_pk_min_u16 v130, v130, v138
    v_pk_min_u16 v131, v131, v139
    s_add_u32 m0, m0, 0x400
    s_add_u32 s37, s37, 0x4000
    buffer_load_dwordx4 v9, s[48:51], s37 offen lds
    v_pk_max_u16 v132, v132, v140
    v_pk_max_u16 v133, v133, v141
    v_pk_max_u16 v134, v134, v142
    v_pk_max_u16 v135, v135, v143
    v_pk_max_u16 v128, v128, v132
    v_pk_max_u16 v129, v129, v133
    v_pk_max_u16 v130, v130, v134
    v_pk_max_u16 v131, v131, v135
    v_pk_sub_i16 v112, v112, v128
    v_pk_sub_i16 v113, v113, v129
    v_pk_sub_i16 v114, v114, v130
    v_pk_sub_i16 v115, v115, v131
    s_add_u32 m0, m0, 0x400
    s_add_u32 s37, s37, 0x4000
    buffer_load_dwordx4 v8, s[48:51], s37 offen lds
    v_pk_ashrrev_i16 v112, s19, v112
    v_pk_ashrrev_i16 v113, s19, v113
    v_pk_ashrrev_i16 v114, s19, v114
    v_pk_ashrrev_i16 v115, s19, v115
    v_bfi_b32 v112, v112, 0, v64
    v_bfi_b32 v113, v113, 0, v65
    v_bfi_b32 v114, v114, 0, v66
    v_bfi_b32 v115, v115, 0, v67
    ds_write_b128 v16, v[112:115] offset:0
    v_pk_sub_i16 v116, v116, v128
    v_pk_sub_i16 v117, v117, v129
    v_pk_sub_i16 v118, v118, v130
    s_add_u32 m0, m0, 0x400
    s_add_u32 s37, s37, 0x4000
    buffer_load_dwordx4 v9, s[48:51], s37 offen lds
    v_pk_sub_i16 v119, v119, v131
    v_pk_ashrrev_i16 v116, s19, v116
    v_pk_ashrrev_i16 v117, s19, v117
    v_pk_ashrrev_i16 v118, s19, v118
    v_pk_ashrrev_i16 v119, s19, v119
    v_bfi_b32 v116, v116, 0, v68
    v_bfi_b32 v117, v117, 0, v69
    v_bfi_b32 v118, v118, 0, v70
    v_bfi_b32 v119, v119, 0, v71
    ds_write_b128 v17, v[116:119] offset:0
    v_pk_sub_i16 v120, v120, v128
    v_pk_sub_i16 v121, v121, v129
    s_add_u32 m0, m0, 0x400
    s_add_u32 s37, s37, 0x4000
    buffer_load_dwordx4 v8, s[48:51], s37 offen lds
    v_pk_sub_i16 v122, v122, v130
    v_pk_sub_i16 v123, v123, v131
    v_pk_ashrrev_i16 v120, s19, v120
    v_pk_ashrrev_i16 v121, s19, v121
    v_pk_ashrrev_i16 v122, s19, v122
    v_pk_ashrrev_i16 v123, s19, v123
    v_bfi_b32 v120, v120, 0, v72
    v_bfi_b32 v121, v121, 0, v73
    v_bfi_b32 v122, v122, 0, v74
    v_bfi_b32 v123, v123, 0, v75
    ds_write_b128 v18, v[120:123] offset:0
    v_pk_sub_i16 v124, v124, v128
    s_add_u32 m0, m0, 0x400
    s_add_u32 s37, s37, 0x4000
    buffer_load_dwordx4 v9, s[48:51], s37 offen lds
    s_add_u32 s32, s32, 128
    s_add_u32 s30, s30, 0x8000
    s_and_b32 s30, s30, 0x1ffff
    v_pk_sub_i16 v125, v125, v129
    v_pk_sub_i16 v126, v126, v130
    v_pk_sub_i16 v127, v127, v131
    v_pk_ashrrev_i16 v124, s19, v124
    v_pk_ashrrev_i16 v125, s19, v125
    v_pk_ashrrev_i16 v126, s19, v126
    v_pk_ashrrev_i16 v127, s19, v127
    v_bfi_b32 v124, v124, 0, v76
    v_bfi_b32 v125, v125, 0, v77
    v_bfi_b32 v126, v126, 0, v78
    v_bfi_b32 v127, v127, 0, v79
    ds_write_b128 v19, v[124:127] offset:0
    buffer_load_dwordx4 v[64:67], v10, s[52:55], s33 offen
    buffer_load_dwordx4 v[68:71], v10, s[52:55], s33 offen offset:2048
    buffer_load_dwordx4 v[72:75], v11, s[52:55], s33 offen
    buffer_load_dwordx4 v[76:79], v11, s[52:55], s33 offen offset:2048
    s_add_u32 s33, s33, 0x20000
    s_waitcnt vmcnt(28) lgkmcnt(0)
    s_barrier
    s_add_u32 s31, s31, 1
    s_cmp_lt_u32 s31, 2
    s_cbranch_scc1 L_prod_loop

    s_waitcnt vmcnt(24)
    s_add_u32 m0, s30, s35
    s_mov_b32 s37, s32
    buffer_load_dwordx4 v8, s[48:51], s37 offen lds
    v_and_b32 v112, 0x7fff7fff, v80
    v_and_b32 v113, 0x7fff7fff, v81
    v_and_b32 v114, 0x7fff7fff, v82
    v_and_b32 v115, 0x7fff7fff, v83
    v_and_b32 v116, 0x7fff7fff, v84
    v_and_b32 v117, 0x7fff7fff, v85
    v_and_b32 v118, 0x7fff7fff, v86
    v_and_b32 v119, 0x7fff7fff, v87
    v_and_b32 v120, 0x7fff7fff, v88
    v_and_b32 v121, 0x7fff7fff, v89
    v_and_b32 v122, 0x7fff7fff, v90
    v_and_b32 v123, 0x7fff7fff, v91
    s_add_u32 m0, m0, 0x400
    s_add_u32 s37, s37, 0x4000
    buffer_load_dwordx4 v9, s[48:51], s37 offen lds
    v_and_b32 v124, 0x7fff7fff, v92
    v_and_b32 v125, 0x7fff7fff, v93
    v_and_b32 v126, 0x7fff7fff, v94
    v_and_b32 v127, 0x7fff7fff, v95
    v_pk_max_u16 v128, v112, v116
    v_pk_max_u16 v129, v113, v117
    v_pk_max_u16 v130, v114, v118
    v_pk_max_u16 v131, v115, v119
    v_pk_min_u16 v132, v112, v116
    v_pk_min_u16 v133, v113, v117
    v_pk_min_u16 v134, v114, v118
    v_pk_min_u16 v135, v115, v119
    s_add_u32 m0, m0, 0x400
    s_add_u32 s37, s37, 0x4000
    buffer_load_dwordx4 v8, s[48:51], s37 offen lds
    v_pk_max_u16 v136, v120, v124
    v_pk_max_u16 v137, v121, v125
    v_pk_max_u16 v138, v122, v126
    v_pk_max_u16 v139, v123, v127
    v_pk_min_u16 v140, v120, v124
    v_pk_min_u16 v141, v121, v125
    v_pk_min_u16 v142, v122, v126
    v_pk_min_u16 v143, v123, v127
    v_pk_min_u16 v128, v128, v136
    v_pk_min_u16 v129, v129, v137
    v_pk_min_u16 v130, v130, v138
    v_pk_min_u16 v131, v131, v139
    s_add_u32 m0, m0, 0x400
    s_add_u32 s37, s37, 0x4000
    buffer_load_dwordx4 v9, s[48:51], s37 offen lds
    v_pk_max_u16 v132, v132, v140
    v_pk_max_u16 v133, v133, v141
    v_pk_max_u16 v134, v134, v142
    v_pk_max_u16 v135, v135, v143
    v_pk_max_u16 v128, v128, v132
    v_pk_max_u16 v129, v129, v133
    v_pk_max_u16 v130, v130, v134
    v_pk_max_u16 v131, v131, v135
    v_pk_sub_i16 v112, v112, v128
    v_pk_sub_i16 v113, v113, v129
    v_pk_sub_i16 v114, v114, v130
    v_pk_sub_i16 v115, v115, v131
    s_add_u32 m0, m0, 0x400
    s_add_u32 s37, s37, 0x4000
    buffer_load_dwordx4 v8, s[48:51], s37 offen lds
    v_pk_ashrrev_i16 v112, s19, v112
    v_pk_ashrrev_i16 v113, s19, v113
    v_pk_ashrrev_i16 v114, s19, v114
    v_pk_ashrrev_i16 v115, s19, v115
    v_bfi_b32 v112, v112, 0, v80
    v_bfi_b32 v113, v113, 0, v81
    v_bfi_b32 v114, v114, 0, v82
    v_bfi_b32 v115, v115, 0, v83
    ds_write_b128 v16, v[112:115] offset:16384
    v_pk_sub_i16 v116, v116, v128
    v_pk_sub_i16 v117, v117, v129
    v_pk_sub_i16 v118, v118, v130
    s_add_u32 m0, m0, 0x400
    s_add_u32 s37, s37, 0x4000
    buffer_load_dwordx4 v9, s[48:51], s37 offen lds
    v_pk_sub_i16 v119, v119, v131
    v_pk_ashrrev_i16 v116, s19, v116
    v_pk_ashrrev_i16 v117, s19, v117
    v_pk_ashrrev_i16 v118, s19, v118
    v_pk_ashrrev_i16 v119, s19, v119
    v_bfi_b32 v116, v116, 0, v84
    v_bfi_b32 v117, v117, 0, v85
    v_bfi_b32 v118, v118, 0, v86
    v_bfi_b32 v119, v119, 0, v87
    ds_write_b128 v17, v[116:119] offset:16384
    v_pk_sub_i16 v120, v120, v128
    v_pk_sub_i16 v121, v121, v129
    s_add_u32 m0, m0, 0x400
    s_add_u32 s37, s37, 0x4000
    buffer_load_dwordx4 v8, s[48:51], s37 offen lds
    v_pk_sub_i16 v122, v122, v130
    v_pk_sub_i16 v123, v123, v131
    v_pk_ashrrev_i16 v120, s19, v120
    v_pk_ashrrev_i16 v121, s19, v121
    v_pk_ashrrev_i16 v122, s19, v122
    v_pk_ashrrev_i16 v123, s19, v123
    v_bfi_b32 v120, v120, 0, v88
    v_bfi_b32 v121, v121, 0, v89
    v_bfi_b32 v122, v122, 0, v90
    v_bfi_b32 v123, v123, 0, v91
    ds_write_b128 v18, v[120:123] offset:16384
    v_pk_sub_i16 v124, v124, v128
    s_add_u32 m0, m0, 0x400
    s_add_u32 s37, s37, 0x4000
    buffer_load_dwordx4 v9, s[48:51], s37 offen lds
    s_add_u32 s32, s32, 128
    s_add_u32 s30, s30, 0x8000
    s_and_b32 s30, s30, 0x1ffff
    v_pk_sub_i16 v125, v125, v129
    v_pk_sub_i16 v126, v126, v130
    v_pk_sub_i16 v127, v127, v131
    v_pk_ashrrev_i16 v124, s19, v124
    v_pk_ashrrev_i16 v125, s19, v125
    v_pk_ashrrev_i16 v126, s19, v126
    v_pk_ashrrev_i16 v127, s19, v127
    v_bfi_b32 v124, v124, 0, v92
    v_bfi_b32 v125, v125, 0, v93
    v_bfi_b32 v126, v126, 0, v94
    v_bfi_b32 v127, v127, 0, v95
    ds_write_b128 v19, v[124:127] offset:16384
    s_waitcnt vmcnt(24) lgkmcnt(0)
    s_barrier
    s_waitcnt vmcnt(20)
    v_and_b32 v112, 0x7fff7fff, v96
    v_and_b32 v113, 0x7fff7fff, v97
    v_and_b32 v114, 0x7fff7fff, v98
    v_and_b32 v115, 0x7fff7fff, v99
    v_and_b32 v116, 0x7fff7fff, v100
    v_and_b32 v117, 0x7fff7fff, v101
    v_and_b32 v118, 0x7fff7fff, v102
    v_and_b32 v119, 0x7fff7fff, v103
    v_and_b32 v120, 0x7fff7fff, v104
    v_and_b32 v121, 0x7fff7fff, v105
    v_and_b32 v122, 0x7fff7fff, v106
    v_and_b32 v123, 0x7fff7fff, v107
    v_and_b32 v124, 0x7fff7fff, v108
    v_and_b32 v125, 0x7fff7fff, v109
    v_and_b32 v126, 0x7fff7fff, v110
    v_and_b32 v127, 0x7fff7fff, v111
    v_pk_max_u16 v128, v112, v116
    v_pk_max_u16 v129, v113, v117
    v_pk_max_u16 v130, v114, v118
    v_pk_max_u16 v131, v115, v119
    v_pk_min_u16 v132, v112, v116
    v_pk_min_u16 v133, v113, v117
    v_pk_min_u16 v134, v114, v118
    v_pk_min_u16 v135, v115, v119
    v_pk_max_u16 v136, v120, v124
    v_pk_max_u16 v137, v121, v125
    v_pk_max_u16 v138, v122, v126
    v_pk_max_u16 v139, v123, v127
    v_pk_min_u16 v140, v120, v124
    v_pk_min_u16 v141, v121, v125
    v_pk_min_u16 v142, v122, v126
    v_pk_min_u16 v143, v123, v127
    v_pk_min_u16 v128, v128, v136
    v_pk_min_u16 v129, v129, v137
    v_pk_min_u16 v130, v130, v138
    v_pk_min_u16 v131, v131, v139
    v_pk_max_u16 v132, v132, v140
    v_pk_max_u16 v133, v133, v141
    v_pk_max_u16 v134, v134, v142
    v_pk_max_u16 v135, v135, v143
    v_pk_max_u16 v128, v128, v132
    v_pk_max_u16 v129, v129, v133
    v_pk_max_u16 v130, v130, v134
    v_pk_max_u16 v131, v131, v135
    v_pk_sub_i16 v112, v112, v128
    v_pk_sub_i16 v113, v113, v129
    v_pk_sub_i16 v114, v114, v130
    v_pk_sub_i16 v115, v115, v131
    v_pk_ashrrev_i16 v112, s19, v112
    v_pk_ashrrev_i16 v113, s19, v113
    v_pk_ashrrev_i16 v114, s19, v114
    v_pk_ashrrev_i16 v115, s19, v115
    v_bfi_b32 v112, v112, 0, v96
    v_bfi_b32 v113, v113, 0, v97
    v_bfi_b32 v114, v114, 0, v98
    v_bfi_b32 v115, v115, 0, v99
    ds_write_b128 v16, v[112:115] offset:0
    v_pk_sub_i16 v116, v116, v128
    v_pk_sub_i16 v117, v117, v129
    v_pk_sub_i16 v118, v118, v130
    v_pk_sub_i16 v119, v119, v131
    v_pk_ashrrev_i16 v116, s19, v116
    v_pk_ashrrev_i16 v117, s19, v117
    v_pk_ashrrev_i16 v118, s19, v118
    v_pk_ashrrev_i16 v119, s19, v119
    v_bfi_b32 v116, v116, 0, v100
    v_bfi_b32 v117, v117, 0, v101
    v_bfi_b32 v118, v118, 0, v102
    v_bfi_b32 v119, v119, 0, v103
    ds_write_b128 v17, v[116:119] offset:0
    v_pk_sub_i16 v120, v120, v128
    v_pk_sub_i16 v121, v121, v129
    v_pk_sub_i16 v122, v122, v130
    v_pk_sub_i16 v123, v123, v131
    v_pk_ashrrev_i16 v120, s19, v120
    v_pk_ashrrev_i16 v121, s19, v121
    v_pk_ashrrev_i16 v122, s19, v122
    v_pk_ashrrev_i16 v123, s19, v123
    v_bfi_b32 v120, v120, 0, v104
    v_bfi_b32 v121, v121, 0, v105
    v_bfi_b32 v122, v122, 0, v106
    v_bfi_b32 v123, v123, 0, v107
    ds_write_b128 v18, v[120:123] offset:0
    v_pk_sub_i16 v124, v124, v128
    v_pk_sub_i16 v125, v125, v129
    v_pk_sub_i16 v126, v126, v130
    v_pk_sub_i16 v127, v127, v131
    v_pk_ashrrev_i16 v124, s19, v124
    v_pk_ashrrev_i16 v125, s19, v125
    v_pk_ashrrev_i16 v126, s19, v126
    v_pk_ashrrev_i16 v127, s19, v127
    v_bfi_b32 v124, v124, 0, v108
    v_bfi_b32 v125, v125, 0, v109
    v_bfi_b32 v126, v126, 0, v110
    v_bfi_b32 v127, v127, 0, v111
    ds_write_b128 v19, v[124:127] offset:0
    s_waitcnt vmcnt(12) lgkmcnt(0)
    s_barrier
    s_waitcnt vmcnt(8)
    v_and_b32 v112, 0x7fff7fff, v64
    v_and_b32 v113, 0x7fff7fff, v65
    v_and_b32 v114, 0x7fff7fff, v66
    v_and_b32 v115, 0x7fff7fff, v67
    v_and_b32 v116, 0x7fff7fff, v68
    v_and_b32 v117, 0x7fff7fff, v69
    v_and_b32 v118, 0x7fff7fff, v70
    v_and_b32 v119, 0x7fff7fff, v71
    v_and_b32 v120, 0x7fff7fff, v72
    v_and_b32 v121, 0x7fff7fff, v73
    v_and_b32 v122, 0x7fff7fff, v74
    v_and_b32 v123, 0x7fff7fff, v75
    v_and_b32 v124, 0x7fff7fff, v76
    v_and_b32 v125, 0x7fff7fff, v77
    v_and_b32 v126, 0x7fff7fff, v78
    v_and_b32 v127, 0x7fff7fff, v79
    v_pk_max_u16 v128, v112, v116
    v_pk_max_u16 v129, v113, v117
    v_pk_max_u16 v130, v114, v118
    v_pk_max_u16 v131, v115, v119
    v_pk_min_u16 v132, v112, v116
    v_pk_min_u16 v133, v113, v117
    v_pk_min_u16 v134, v114, v118
    v_pk_min_u16 v135, v115, v119
    v_pk_max_u16 v136, v120, v124
    v_pk_max_u16 v137, v121, v125
    v_pk_max_u16 v138, v122, v126
    v_pk_max_u16 v139, v123, v127
    v_pk_min_u16 v140, v120, v124
    v_pk_min_u16 v141, v121, v125
    v_pk_min_u16 v142, v122, v126
    v_pk_min_u16 v143, v123, v127
    v_pk_min_u16 v128, v128, v136
    v_pk_min_u16 v129, v129, v137
    v_pk_min_u16 v130, v130, v138
    v_pk_min_u16 v131, v131, v139
    v_pk_max_u16 v132, v132, v140
    v_pk_max_u16 v133, v133, v141
    v_pk_max_u16 v134, v134, v142
    v_pk_max_u16 v135, v135, v143
    v_pk_max_u16 v128, v128, v132
    v_pk_max_u16 v129, v129, v133
    v_pk_max_u16 v130, v130, v134
    v_pk_max_u16 v131, v131, v135
    v_pk_sub_i16 v112, v112, v128
    v_pk_sub_i16 v113, v113, v129
    v_pk_sub_i16 v114, v114, v130
    v_pk_sub_i16 v115, v115, v131
    v_pk_ashrrev_i16 v112, s19, v112
    v_pk_ashrrev_i16 v113, s19, v113
    v_pk_ashrrev_i16 v114, s19, v114
    v_pk_ashrrev_i16 v115, s19, v115
    v_bfi_b32 v112, v112, 0, v64
    v_bfi_b32 v113, v113, 0, v65
    v_bfi_b32 v114, v114, 0, v66
    v_bfi_b32 v115, v115, 0, v67
    ds_write_b128 v16, v[112:115] offset:16384
    v_pk_sub_i16 v116, v116, v128
    v_pk_sub_i16 v117, v117, v129
    v_pk_sub_i16 v118, v118, v130
    v_pk_sub_i16 v119, v119, v131
    v_pk_ashrrev_i16 v116, s19, v116
    v_pk_ashrrev_i16 v117, s19, v117
    v_pk_ashrrev_i16 v118, s19, v118
    v_pk_ashrrev_i16 v119, s19, v119
    v_bfi_b32 v116, v116, 0, v68
    v_bfi_b32 v117, v117, 0, v69
    v_bfi_b32 v118, v118, 0, v70
    v_bfi_b32 v119, v119, 0, v71
    ds_write_b128 v17, v[116:119] offset:16384
    v_pk_sub_i16 v120, v120, v128
    v_pk_sub_i16 v121, v121, v129
    v_pk_sub_i16 v122, v122, v130
    v_pk_sub_i16 v123, v123, v131
    v_pk_ashrrev_i16 v120, s19, v120
    v_pk_ashrrev_i16 v121, s19, v121
    v_pk_ashrrev_i16 v122, s19, v122
    v_pk_ashrrev_i16 v123, s19, v123
    v_bfi_b32 v120, v120, 0, v72
    v_bfi_b32 v121, v121, 0, v73
    v_bfi_b32 v122, v122, 0, v74
    v_bfi_b32 v123, v123, 0, v75
    ds_write_b128 v18, v[120:123] offset:16384
    v_pk_sub_i16 v124, v124, v128
    v_pk_sub_i16 v125, v125, v129
    v_pk_sub_i16 v126, v126, v130
    v_pk_sub_i16 v127, v127, v131
    v_pk_ashrrev_i16 v124, s19, v124
    v_pk_ashrrev_i16 v125, s19, v125
    v_pk_ashrrev_i16 v126, s19, v126
    v_pk_ashrrev_i16 v127, s19, v127
    v_bfi_b32 v124, v124, 0, v76
    v_bfi_b32 v125, v125, 0, v77
    v_bfi_b32 v126, v126, 0, v78
    v_bfi_b32 v127, v127, 0, v79
    ds_write_b128 v19, v[124:127] offset:16384
    s_waitcnt vmcnt(0) lgkmcnt(0)
    s_barrier
L_done:
    s_endpgm
.section .rodata,"a"
.p2align 6
.amdhsa_kernel standalone__structured_sparse_n_m__ragged_kernel
  .amdhsa_next_free_vgpr 256
  .amdhsa_next_free_sgpr 96
  .amdhsa_accum_offset 256
  .amdhsa_group_segment_fixed_size 0
  .amdhsa_kernarg_size 48
  .amdhsa_user_sgpr_count 2
  .amdhsa_user_sgpr_kernarg_segment_ptr 1
  .amdhsa_system_sgpr_workgroup_id_x 1
.end_amdhsa_kernel
```
